```python
import torch

def _softmax(x, axis=-1):
    return torch.softmax(x, dim=axis)
def _gelu(x):
    return torch.nn.functional.gelu(x, approximate="tanh")
def _silu(x):
    return torch.nn.functional.silu(x)
def _sigmoid(x):
    return torch.sigmoid(x)
def _layernorm(x, axis=-1, eps=1e-5):
    m = x.mean(dim=axis, keepdim=True)
    v = x.var(dim=axis, keepdim=True, unbiased=False)
    return (x - m) / torch.sqrt(v + eps)
def _scatter_add(tgt, idx, src, axis=0):
    return tgt.clone().index_add_(axis, idx, src)
def _segment_sum(src, seg, n):
    out = torch.zeros((n,) + src.shape[1:], dtype=src.dtype)
    return out.index_add_(0, seg, src)
def _pad(x, pw):
    flat = tuple(v for pair in reversed(pw) for v in pair)
    return torch.nn.functional.pad(x, flat)

kernel_name = 'recurrent_scan__gqa_block_cached__glu_gated_swiglu__decode'

def setup_inputs():

    _w = (lambda a: (lambda t: t.to(torch.bfloat16) if t.is_floating_point() else t)(torch.as_tensor(a)))
    def _A_setup():
        B, Sq, D = 4, 1, 448
        Hq, Hkv, Sk, Dh = 16, 8, 4096, 256
        assert Hq % Hkv == 0, (Hq, Hkv)
        return {
            "x": _w((lambda *s: torch.randn(*s, dtype=torch.bfloat16) * 0.05)(B, Sq, D)),
            "k_cache": _w((lambda *s: torch.randn(*s, dtype=torch.bfloat16) * 3.2)(B, Hkv, Sk, Dh)),
            "v_cache": _w((lambda *s: torch.randn(*s, dtype=torch.bfloat16) * 3.2)(B, Hkv, Sk, Dh)),
            "wq": _w((lambda *s: torch.randn(*s, dtype=torch.bfloat16) * 3.2)(D, Hq * Dh) * (D ** -0.5)),
            "wo": _w((lambda *s: torch.randn(*s, dtype=torch.bfloat16) * 3.2)(Hq * Dh, D) * ((Hq * Dh) ** -0.5)),
        }
    _A_in = _A_setup()

    def _B_setup():
        B, S, D, F = 4, 1, 448, 1792
        return {
            "x": _w((lambda *s: torch.randn(*s, dtype=torch.bfloat16) * 0.05)(B, S, D)),
            "w1": _w((lambda *s: torch.randn(*s, dtype=torch.bfloat16) * 0.4)(D, F) * (2.0 / D) ** 0.5),
            "w3": _w((lambda *s: torch.randn(*s, dtype=torch.bfloat16) * 0.4)(D, F) * (2.0 / D) ** 0.5),
            "w2": _w((lambda *s: torch.randn(*s, dtype=torch.bfloat16) * 0.4)(F, D) * (2.0 / F) ** 0.5),
        }
    _B_in = _B_setup()

    return {
        "A_x": _A_in["x"],
        "A_k_cache": _A_in["k_cache"],
        "A_v_cache": _A_in["v_cache"],
        "A_wq": _A_in["wq"],
        "A_wo": _A_in["wo"],
        "B_x": _B_in["x"],
        "B_w1": _B_in["w1"],
        "B_w3": _B_in["w3"],
        "B_w2": _B_in["w2"],
    }

def reference(A_x, A_k_cache, A_v_cache, A_wq, A_wo, B_x, B_w1, B_w3, B_w2):
    def _A_ref(x, k_cache, v_cache, wq, wo):
        B, Sq, D = x.shape
        Hq, Dh = 16, 256
        Hkv = k_cache.shape[1]
        rep = Hq // Hkv
        q = (lambda x, *d: x.permute(*d))((x @ wq).reshape(B, Sq, Hq, Dh), 0, 2, 1, 3)
        k = (lambda x, n, axis: torch.repeat_interleave(x, n, dim=axis))(k_cache, rep, axis=1)
        v = (lambda x, n, axis: torch.repeat_interleave(x, n, dim=axis))(v_cache, rep, axis=1)
        scores = torch.einsum("bhqd,bhkd->bhqk", q, k) * (Dh ** -0.5)
        p = _softmax(scores, axis=-1)
        o = torch.einsum("bhqk,bhkd->bhqd", p, v)
        return (lambda x, *d: x.permute(*d))(o, 0, 2, 1, 3).reshape(B, Sq, Hq * Dh) @ wo

    def _B_ref(x, w1, w3, w2):
        gate = torch.einsum("bsd,df->bsf", x, w1)
        up = torch.einsum("bsd,df->bsf", x, w3)
        h = _silu(gate) * up
        out = torch.einsum("bsf,fd->bsd", h, w2)
        return out

    x = A_x
    xn = _layernorm(x, axis=-1)
    s = _A_ref(xn, A_k_cache, A_v_cache, A_wq, A_wo)
    g = _silu(_B_ref(xn, B_w1, B_w3, B_w2))
    return x + s * g
```

```asm
; @launch grid=(256,1,1) block=(448,1,1) lds=163584
.amdgcn_target "amdgcn-amd-amdhsa--gfx950"
.text
.globl recurrent_scan__gqa_block_cached__glu_gated_swiglu__decode_kernel
.p2align 12
.p2align 8
.type recurrent_scan__gqa_block_cached__glu_gated_swiglu__decode_kernel,@function
recurrent_scan__gqa_block_cached__glu_gated_swiglu__decode_kernel:
    s_cmp_ge_u32 s2, 256
    s_cbranch_scc1 L_end
    s_load_dwordx16 s[8:23], s[0:1], 0
    s_load_dwordx8 s[24:31], s[0:1], 64
    v_lshrrev_b32 v1, 6, v0
    v_and_b32 v0, 63, v0
    v_readfirstlane_b32 s3, v1
    s_and_b32 s4, s2, 7
    s_lshr_b32 s5, s2, 3
    s_and_b32 s6, s5, 3
    s_lshr_b32 s7, s5, 2
    s_mul_i32 s48, s4, 7
    s_mul_i32 s49, s4, 7
    s_add_u32 s49, s49, 0
    s_cmp_lt_u32 s4, 4
    s_cselect_b32 s48, s48, s49
    s_cselect_b32 s34, 17, 17
    s_cmp_eq_u32 s4, 7
    s_cselect_b32 s34, 17, s34
    s_cselect_b32 s55, 0, 14
    s_cmp_lt_u32 s5, s55
    s_cselect_b32 s35, 4, 0
    s_add_u32 s48, s48, s5
    s_sub_u32 s48, s48, s34
    s_sub_u32 s49, s48, 28
    s_cmp_lt_u32 s48, 28
    s_cselect_b32 s49, s48, s49
    s_cselect_b32 s48, 2, 3
    s_cmp_ge_u32 s5, s34
    s_cselect_b32 s35, s48, s35
    s_lshl_b32 s48, s4, 3
    s_add_u32 s48, s48, s5
    s_sub_u32 s48, s48, 24
    s_movk_i32 s57, 3584
    s_mov_b32 s38, 1605632
    s_cmp_ge_u32 s5, 24
    s_cselect_b32 s35, 1, s35
    s_cselect_b32 s49, s48, s49
    s_cselect_b32 s57, 8192, s57
    s_cselect_b32 s38, 3670016, s38
    s_mov_b32 s39, 0x20000
    s_mul_i32 s55, s5, 896
    s_add_u32 s55, s55, s4
    s_cmp_eq_u32 s35, 4
    s_cselect_b32 s48, s55, s49
    s_cselect_b32 s57, 896, s57
    s_cselect_b32 s61, 8, 28
    s_cselect_b32 s60, 32, 0
    s_lshl_b32 s48, s48, 7
    s_lshl_b32 s60, s60, 10
    s_add_u32 s60, s60, 98304
    s_cmp_eq_u32 s35, 0
    s_cselect_b32 s61, 0, s61
    s_lshl_b32 s56, s57, 3
    s_lshl_b32 s52, s6, 3
    s_add_u32 s52, s52, s4
    s_lshl_b32 s52, s52, 21
    s_lshl_b32 s53, s7, 18
    s_add_u32 s54, s52, s53
    s_mov_b32 s42, 0x4000000
    s_mov_b32 s43, 0x20000
    v_lshlrev_b32 v9, 4, v0
    v_mov_b32 v10, 155648
    v_lshrrev_b32 v2, 3, v0
    v_and_b32 v3, 7, v0
    v_and_b32 v8, 2, v2
    v_xor_b32 v3, v3, v8
    v_lshlrev_b32 v3, 4, v3
    v_mad_u32_u24 v24, v2, s57, v3
    v_xor_b32 v25, 64, v3
    v_mad_u32_u24 v25, v2, s57, v25
    v_lshrrev_b32 v28, 5, v0
    v_and_b32 v29, 31, v0
    v_lshlrev_b32 v30, 9, v28
    v_xor_b32 v15, v29, v28
    v_lshl_add_u32 v16, v15, 4, v30
    v_xor_b32 v17, 2, v15
    v_lshl_add_u32 v17, v17, 4, v30
    v_xor_b32 v18, 4, v15
    v_lshl_add_u32 v18, v18, 4, v30
    v_xor_b32 v19, 6, v15
    v_lshl_add_u32 v19, v19, 4, v30
    v_xor_b32 v20, 8, v15
    v_lshl_add_u32 v20, v20, 4, v30
    v_xor_b32 v21, 10, v15
    v_lshl_add_u32 v21, v21, 4, v30
    v_xor_b32 v22, 12, v15
    v_lshl_add_u32 v22, v22, 4, v30
    v_xor_b32 v23, 14, v15
    v_lshl_add_u32 v23, v23, 4, v30
    s_mov_b32 s62, 0x100000
    s_cmp_eq_u32 s3, 4
    s_waitcnt lgkmcnt(0)
    s_cbranch_scc0 L_others
    s_cmp_eq_u32 s35, 2
    s_cselect_b32 s36, s20, s22
    s_cselect_b32 s37, s21, s23
    s_cmp_eq_u32 s35, 1
    s_cselect_b32 s36, s14, s36
    s_cselect_b32 s37, s15, s37
    s_cmp_eq_u32 s35, 4
    s_cselect_b32 s36, s24, s36
    s_cselect_b32 s37, s25, s37
    s_mov_b32 m0, s60
    s_mov_b32 s40, s10
    s_mov_b32 s41, s11
    s_setprio 3
    s_mov_b32 s58, 1
    s_cmp_eq_u32 s61, 0
    s_cbranch_scc1 L_ld_kv
L_tile:
    s_waitcnt vmcnt(27)
    buffer_load_dwordx4 v24, s[36:39], s48 offen nt lds
    s_add_u32 m0, m0, 1024
    s_add_u32 s48, s48, s56
    s_waitcnt vmcnt(27)
    buffer_load_dwordx4 v25, s[36:39], s48 offen nt lds
    s_add_u32 m0, m0, 1024
    s_add_u32 s48, s48, s56
    s_sub_u32 s61, s61, 1
    s_cmp_lg_u32 s61, 16
    s_cbranch_scc1 L_tile_nb
    s_barrier
    s_movk_i32 s58, 100
L_tile_nb:
    s_cmp_lg_u32 s61, 0
    s_cbranch_scc1 L_tile
L_ld_kv:
    s_mov_b32 s52, s54
    s_mov_b32 s50, 0
    s_mov_b32 s51, 0
    s_mov_b32 s63, 147456
    s_mov_b32 s53, 5
    s_cmp_eq_u32 s35, 4
    s_cselect_b32 s46, 4, 2
    s_sub_u32 s55, s35, 1
    s_cmp_lt_u32 s55, 3
    s_cselect_b32 s46, 12, s46
    s_cmp_eq_u32 s7, 7
    s_cselect_b32 s46, 8, s46
    s_getreg_b32 s55, hwreg(HW_REG_XCC_ID, 0, 4)
    s_cmp_ge_u32 s55, 4
    s_cselect_b32 s55, 3, 0
    s_add_u32 s46, s46, s55
    s_mov_b32 s47, 0
L_item:
    s_cmp_lg_u32 s50, s58
    s_cbranch_scc1 L_nobar
    s_barrier
L_nobar:
    s_cmp_ge_u32 s50, 2
    s_cbranch_scc1 L_notstart
L_goS:
    s_mov_b32 m0, s51
    s_waitcnt vmcnt(25)
    buffer_load_dwordx4 v16, s[40:43], s52 offen offset:0 nt lds
    s_waitcnt vmcnt(25)
    buffer_load_dwordx4 v17, s[40:43], s52 offen offset:1024 nt lds
    s_waitcnt vmcnt(25)
    buffer_load_dwordx4 v18, s[40:43], s52 offen offset:2048 nt lds
    s_waitcnt vmcnt(25)
    buffer_load_dwordx4 v19, s[40:43], s52 offen offset:3072 nt lds
    s_add_u32 m0, m0, 4096
    s_add_u32 s52, s52, 4096
    s_waitcnt vmcnt(25)
    buffer_load_dwordx4 v20, s[40:43], s52 offen offset:0 nt lds
    s_waitcnt vmcnt(25)
    buffer_load_dwordx4 v21, s[40:43], s52 offen offset:1024 nt lds
    s_waitcnt vmcnt(25)
    buffer_load_dwordx4 v22, s[40:43], s52 offen offset:2048 nt lds
    s_waitcnt vmcnt(25)
    buffer_load_dwordx4 v23, s[40:43], s52 offen offset:3072 nt lds
    s_add_u32 m0, m0, 4096
    s_add_u32 s52, s52, 4096
    s_waitcnt vmcnt(25)
    buffer_load_dwordx4 v16, s[40:43], s52 offen offset:0 nt lds
    s_waitcnt vmcnt(25)
    v_mov_b32 v46, s50
    ds_write_b32 v10, v46 offset:32
    buffer_load_dwordx4 v17, s[40:43], s52 offen offset:1024 nt lds
    s_waitcnt vmcnt(25)
    buffer_load_dwordx4 v18, s[40:43], s52 offen offset:2048 nt lds
    s_waitcnt vmcnt(25)
    buffer_load_dwordx4 v19, s[40:43], s52 offen offset:3072 nt lds
    s_add_u32 m0, m0, 4096
    s_add_u32 s52, s52, 4096
    ds_read_b128 v[40:43], v10 offset:0
    ds_read_b32 v44, v10 offset:16
    s_waitcnt vmcnt(25)
    buffer_load_dwordx4 v20, s[40:43], s52 offen offset:0 nt lds
    s_waitcnt vmcnt(25)
    buffer_load_dwordx4 v21, s[40:43], s52 offen offset:1024 nt lds
    s_waitcnt vmcnt(25)
    buffer_load_dwordx4 v22, s[40:43], s52 offen offset:2048 nt lds
    s_waitcnt vmcnt(25)
    buffer_load_dwordx4 v23, s[40:43], s52 offen offset:3072 nt lds
    s_add_u32 s52, s52, 4096
    s_add_u32 s51, s51, 16384
    s_cmp_eq_u32 s51, s63
    s_cselect_b32 s51, 0, s51
    s_add_u32 s50, s50, 1
    s_cmp_eq_u32 s50, 18
    s_cselect_b32 s63, 81920, s63
    s_cmp_eq_u32 s50, 23
    s_cselect_b32 s53, 1, s53
    s_branch L_item
L_notstart:
    s_cmp_lt_u32 s50, 5
    s_cbranch_scc1 L_levelP
L_checkP:
    s_waitcnt lgkmcnt(0)
    v_min3_u32 v40, v40, v41, v42
    v_min3_u32 v40, v40, v43, v44
    s_sub_u32 s56, s50, s53
    v_readfirstlane_b32 s55, v40
    s_nop 0
    s_cmp_gt_u32 s55, s56
    s_cbranch_scc0 L_slowP
    s_cmp_ge_u32 s50, 30
    s_cbranch_scc1 L_goPb
L_levelP:
    s_and_b32 s47, s47, 3
    s_add_u32 s47, s47, s46
    s_cmp_ge_u32 s47, 16
    s_cbranch_scc1 L_goP4
    s_cmp_ge_u32 s47, 12
    s_cbranch_scc1 L_goP3
    s_cmp_ge_u32 s47, 8
    s_cbranch_scc1 L_goP2
    s_cmp_ge_u32 s47, 4
    s_cbranch_scc1 L_goP1
L_goP:
    s_mov_b32 m0, s51
    s_waitcnt vmcnt(17)
    buffer_load_dwordx4 v16, s[40:43], s52 offen offset:0 nt lds
    s_waitcnt vmcnt(17)
    v_mov_b32 v46, s50
    ds_write_b32 v10, v46 offset:32
    buffer_load_dwordx4 v17, s[40:43], s52 offen offset:1024 nt lds
    s_waitcnt vmcnt(17)
    buffer_load_dwordx4 v18, s[40:43], s52 offen offset:2048 nt lds
    s_waitcnt vmcnt(17)
    buffer_load_dwordx4 v19, s[40:43], s52 offen offset:3072 nt lds
    s_add_u32 m0, m0, 4096
    s_add_u32 s52, s52, 4096
    s_waitcnt vmcnt(17)
    buffer_load_dwordx4 v20, s[40:43], s52 offen offset:0 nt lds
    s_waitcnt vmcnt(17)
    buffer_load_dwordx4 v21, s[40:43], s52 offen offset:1024 nt lds
    s_waitcnt vmcnt(17)
    buffer_load_dwordx4 v22, s[40:43], s52 offen offset:2048 nt lds
    s_waitcnt vmcnt(17)
    buffer_load_dwordx4 v23, s[40:43], s52 offen offset:3072 nt lds
    s_add_u32 m0, m0, 4096
    s_add_u32 s52, s52, 4096
    s_waitcnt vmcnt(17)
    buffer_load_dwordx4 v16, s[40:43], s52 offen offset:0 nt lds
    s_waitcnt vmcnt(17)
    buffer_load_dwordx4 v17, s[40:43], s52 offen offset:1024 nt lds
    s_waitcnt vmcnt(17)
    buffer_load_dwordx4 v18, s[40:43], s52 offen offset:2048 nt lds
    s_waitcnt vmcnt(17)
    buffer_load_dwordx4 v19, s[40:43], s52 offen offset:3072 nt lds
    s_add_u32 m0, m0, 4096
    s_add_u32 s52, s52, 4096
    ds_read_b128 v[40:43], v10 offset:0
    ds_read_b32 v44, v10 offset:16
    s_waitcnt vmcnt(17)
    buffer_load_dwordx4 v20, s[40:43], s52 offen offset:0 nt lds
    s_waitcnt vmcnt(17)
    buffer_load_dwordx4 v21, s[40:43], s52 offen offset:1024 nt lds
    s_waitcnt vmcnt(17)
    buffer_load_dwordx4 v22, s[40:43], s52 offen offset:2048 nt lds
    s_waitcnt vmcnt(17)
    buffer_load_dwordx4 v23, s[40:43], s52 offen offset:3072 nt lds
    s_add_u32 s52, s52, 4096
    s_add_u32 s51, s51, 16384
    s_cmp_eq_u32 s51, s63
    s_cselect_b32 s51, 0, s51
    s_add_u32 s50, s50, 1
    s_cmp_eq_u32 s50, 18
    s_cselect_b32 s63, 81920, s63
    s_cmp_eq_u32 s50, 23
    s_cselect_b32 s53, 1, s53
L_afterP:
    s_cmp_eq_u32 s50, 16
    s_cbranch_scc1 L_tov
    s_cmp_eq_u32 s50, 19
    s_cbranch_scc1 L_towo
L_item_next:
    s_cmp_lt_u32 s50, 32
    s_cbranch_scc1 L_item
    v_mov_b32 v46, 32
    v_mov_b32 v47, 33
    s_waitcnt vmcnt(16)
    ds_write_b32 v10, v46 offset:32
    s_waitcnt vmcnt(0)
    ds_write_b32 v10, v47 offset:32
    s_endpgm
L_others:
    s_load_dword s32, s[30:31], 0
    s_cmp_ge_u32 s3, 4
    s_cbranch_scc1 L_nox
    s_sub_u32 s50, s35, 1
    s_cmp_ge_u32 s50, 3
    s_cbranch_scc1 L_nox
    s_mul_i32 s50, s3, 896
    v_add_u32 v11, s50, v9
    v_mov_b32 v4, 0
    v_mov_b32 v5, 0
    v_mov_b32 v6, 0
    v_mov_b32 v7, 0
    s_mov_b32 exec_hi, 0x00ffffff
    global_load_dwordx4 v[4:7], v11, s[8:9]
    s_mov_b32 exec_hi, -1
L_nox:
    s_sub_u32 s50, s35, 1
    s_cmp_ge_u32 s50, 3
    s_cselect_b32 s51, 1, 0
    s_cselect_b32 s52, 4, 1
    v_mov_b32 v12, s52
    v_mad_u32_u24 v12, v0, s51, v12
    v_cmp_gt_u32 vcc, 4, v0
    s_cmp_eq_u32 s35, 4
    s_cselect_b32 s50, 3, 1000
    v_cndmask_b32 v12, 0, v12, vcc
    v_mov_b32 v13, s50
    v_cmp_eq_u32 vcc, 4, v0
    v_lshl_add_u32 v14, v0, 2, v10
    s_nop 0
    v_cndmask_b32 v12, v12, v13, vcc
    ds_write_b32 v14, v12
    s_waitcnt lgkmcnt(0)
    s_mul_i32 s33, s32, 0x9E3779B1
    s_add_u32 s33, s33, 0x7F4A7C15
    s_barrier
    v_and_b32 v14, 15, v0
    v_lshrrev_b32 v15, 4, v0
    s_cmp_lt_u32 s3, 4
    s_cbranch_scc1 L_C
    s_cmp_eq_u32 s3, 5
    s_cbranch_scc1 L_Q
    s_branch L_F
L_slowP:
    s_sub_u32 s62, s62, 1
    s_cbranch_scc1 L_fail
    ds_read_b128 v[40:43], v10 offset:0
    ds_read_b32 v44, v10 offset:16
    s_branch L_checkP
L_tov:
    s_mov_b32 s40, s12
    s_mov_b32 s41, s13
    s_mov_b32 s52, s54
    v_lshlrev_b32 v15, 1, v28
    v_xor_b32 v15, v15, v29
    v_xor_b32 v16, 0, v15
    v_lshl_add_u32 v16, v16, 4, v30
    v_xor_b32 v17, 4, v15
    v_lshl_add_u32 v17, v17, 4, v30
    v_xor_b32 v18, 0, v15
    v_lshl_add_u32 v18, v18, 4, v30
    v_xor_b32 v19, 4, v15
    v_lshl_add_u32 v19, v19, 4, v30
    v_xor_b32 v20, 8, v15
    v_lshl_add_u32 v20, v20, 4, v30
    v_xor_b32 v21, 12, v15
    v_lshl_add_u32 v21, v21, 4, v30
    v_xor_b32 v22, 8, v15
    v_lshl_add_u32 v22, v22, 4, v30
    v_xor_b32 v23, 12, v15
    v_lshl_add_u32 v23, v23, 4, v30
    s_mov_b32 s36, s16
    s_mov_b32 s37, s17
    s_mov_b32 s38, 3670016
    s_mul_i32 s48, s4, 458752
    s_lshl_b32 s55, s7, 7
    s_add_u32 s48, s48, s55
    s_movk_i32 s57, 896
    s_mov_b32 s60, 81920
    v_mad_u32_u24 v24, v2, s57, v3
    v_xor_b32 v25, 64, v3
    v_mad_u32_u24 v25, v2, s57, v25
    s_branch L_item
L_towo:
    s_cmp_eq_u32 s7, 7
    s_cbranch_scc1 L_item
L_itemW:
L_checkW:
    s_waitcnt lgkmcnt(0)
    v_min3_u32 v40, v40, v41, v42
    v_min3_u32 v40, v40, v43, v44
    s_sub_u32 s56, s50, s53
    s_max_u32 s56, s56, 19
    v_readfirstlane_b32 s55, v40
    s_nop 0
    s_cmp_gt_u32 s55, s56
    s_cbranch_scc0 L_slowW
    s_and_b32 s47, s47, 3
    s_add_u32 s47, s47, s46
    s_cmp_ge_u32 s47, 16
    s_cbranch_scc1 L_goW4
    s_cmp_ge_u32 s47, 12
    s_cbranch_scc1 L_goW3
    s_cmp_ge_u32 s47, 8
    s_cbranch_scc1 L_goW2
    s_cmp_ge_u32 s47, 4
    s_cbranch_scc1 L_goW1
L_goW:
    s_mov_b32 m0, s60
    s_waitcnt vmcnt(23)
    buffer_load_dwordx4 v24, s[36:39], s48 offen nt lds
    s_add_u32 m0, m0, 1024
    s_add_u32 s48, s48, 7168
    s_waitcnt vmcnt(23)
    buffer_load_dwordx4 v25, s[36:39], s48 offen nt lds
    s_add_u32 m0, m0, 1024
    s_add_u32 s48, s48, 7168
    s_waitcnt vmcnt(23)
    buffer_load_dwordx4 v24, s[36:39], s48 offen nt lds
    s_add_u32 m0, m0, 1024
    s_add_u32 s48, s48, 7168
    s_waitcnt vmcnt(23)
    buffer_load_dwordx4 v25, s[36:39], s48 offen nt lds
    s_add_u32 m0, m0, 1024
    s_add_u32 s48, s48, 7168
    s_waitcnt vmcnt(23)
    buffer_load_dwordx4 v24, s[36:39], s48 offen nt lds
    s_add_u32 m0, m0, 1024
    s_add_u32 s48, s48, 7168
    s_waitcnt vmcnt(23)
    buffer_load_dwordx4 v25, s[36:39], s48 offen nt lds
    s_add_u32 m0, m0, 1024
    s_add_u32 s48, s48, 7168
    s_mov_b32 s60, m0
    s_mov_b32 m0, s51
    s_waitcnt vmcnt(23)
    buffer_load_dwordx4 v16, s[40:43], s52 offen offset:0 nt lds
    s_waitcnt vmcnt(23)
    v_mov_b32 v46, s50
    ds_write_b32 v10, v46 offset:32
    buffer_load_dwordx4 v17, s[40:43], s52 offen offset:1024 nt lds
    s_waitcnt vmcnt(23)
    buffer_load_dwordx4 v18, s[40:43], s52 offen offset:2048 nt lds
    s_waitcnt vmcnt(23)
    buffer_load_dwordx4 v19, s[40:43], s52 offen offset:3072 nt lds
    s_add_u32 m0, m0, 4096
    s_add_u32 s52, s52, 4096
    s_waitcnt vmcnt(23)
    buffer_load_dwordx4 v20, s[40:43], s52 offen offset:0 nt lds
    s_waitcnt vmcnt(23)
    buffer_load_dwordx4 v21, s[40:43], s52 offen offset:1024 nt lds
    s_waitcnt vmcnt(23)
    buffer_load_dwordx4 v22, s[40:43], s52 offen offset:2048 nt lds
    s_waitcnt vmcnt(23)
    buffer_load_dwordx4 v23, s[40:43], s52 offen offset:3072 nt lds
    s_add_u32 m0, m0, 4096
    s_add_u32 s52, s52, 4096
    s_waitcnt vmcnt(23)
    buffer_load_dwordx4 v16, s[40:43], s52 offen offset:0 nt lds
    s_waitcnt vmcnt(23)
    buffer_load_dwordx4 v17, s[40:43], s52 offen offset:1024 nt lds
    s_waitcnt vmcnt(23)
    buffer_load_dwordx4 v18, s[40:43], s52 offen offset:2048 nt lds
    s_waitcnt vmcnt(23)
    buffer_load_dwordx4 v19, s[40:43], s52 offen offset:3072 nt lds
    s_add_u32 m0, m0, 4096
    s_add_u32 s52, s52, 4096
    ds_read_b128 v[40:43], v10 offset:0
    ds_read_b32 v44, v10 offset:16
    s_waitcnt vmcnt(23)
    buffer_load_dwordx4 v20, s[40:43], s52 offen offset:0 nt lds
    s_waitcnt vmcnt(23)
    buffer_load_dwordx4 v21, s[40:43], s52 offen offset:1024 nt lds
    s_waitcnt vmcnt(23)
    buffer_load_dwordx4 v22, s[40:43], s52 offen offset:2048 nt lds
    s_waitcnt vmcnt(23)
    buffer_load_dwordx4 v23, s[40:43], s52 offen offset:3072 nt lds
    s_add_u32 s52, s52, 4096
    s_add_u32 s51, s51, 16384
    s_cmp_eq_u32 s51, s63
    s_cselect_b32 s51, 0, s51
    s_add_u32 s50, s50, 1
    s_cmp_eq_u32 s50, 18
    s_cselect_b32 s63, 81920, s63
    s_cmp_eq_u32 s50, 23
    s_cselect_b32 s53, 1, s53
L_afterW:
    s_cmp_lt_u32 s50, 30
    s_cbranch_scc1 L_itemW
    s_branch L_item_next
L_slowW:
    s_sub_u32 s62, s62, 1
    s_cbranch_scc1 L_fail
    ds_read_b128 v[40:43], v10 offset:0
    ds_read_b32 v44, v10 offset:16
    s_branch L_checkW
L_goPb:
    s_mov_b32 m0, s51
    s_waitcnt vmcnt(29)
    buffer_load_dwordx4 v16, s[40:43], s52 offen offset:0 nt lds
    s_waitcnt vmcnt(29)
    buffer_load_dwordx4 v17, s[40:43], s52 offen offset:1024 nt lds
    s_waitcnt vmcnt(29)
    buffer_load_dwordx4 v18, s[40:43], s52 offen offset:2048 nt lds
    s_waitcnt vmcnt(29)
    buffer_load_dwordx4 v19, s[40:43], s52 offen offset:3072 nt lds
    s_add_u32 m0, m0, 4096
    s_add_u32 s52, s52, 4096
    s_waitcnt vmcnt(29)
    buffer_load_dwordx4 v20, s[40:43], s52 offen offset:0 nt lds
    s_waitcnt vmcnt(29)
    buffer_load_dwordx4 v21, s[40:43], s52 offen offset:1024 nt lds
    s_waitcnt vmcnt(29)
    buffer_load_dwordx4 v22, s[40:43], s52 offen offset:2048 nt lds
    s_waitcnt vmcnt(29)
    buffer_load_dwordx4 v23, s[40:43], s52 offen offset:3072 nt lds
    s_add_u32 m0, m0, 4096
    s_add_u32 s52, s52, 4096
    s_waitcnt vmcnt(29)
    buffer_load_dwordx4 v16, s[40:43], s52 offen offset:0 nt lds
    s_waitcnt vmcnt(29)
    buffer_load_dwordx4 v17, s[40:43], s52 offen offset:1024 nt lds
    s_waitcnt vmcnt(29)
    buffer_load_dwordx4 v18, s[40:43], s52 offen offset:2048 nt lds
    s_waitcnt vmcnt(29)
    buffer_load_dwordx4 v19, s[40:43], s52 offen offset:3072 nt lds
    s_add_u32 m0, m0, 4096
    s_add_u32 s52, s52, 4096
    ds_read_b128 v[40:43], v10 offset:0
    ds_read_b32 v44, v10 offset:16
    s_waitcnt vmcnt(29)
    buffer_load_dwordx4 v20, s[40:43], s52 offen offset:0 nt lds
    s_waitcnt vmcnt(29)
    v_mov_b32 v46, s50
    ds_write_b32 v10, v46 offset:32
    buffer_load_dwordx4 v21, s[40:43], s52 offen offset:1024 nt lds
    s_waitcnt vmcnt(29)
    buffer_load_dwordx4 v22, s[40:43], s52 offen offset:2048 nt lds
    s_waitcnt vmcnt(29)
    buffer_load_dwordx4 v23, s[40:43], s52 offen offset:3072 nt lds
    s_add_u32 s52, s52, 4096
    s_add_u32 s51, s51, 16384
    s_cmp_eq_u32 s51, s63
    s_cselect_b32 s51, 0, s51
    s_add_u32 s50, s50, 1
    s_cmp_eq_u32 s50, 18
    s_cselect_b32 s63, 81920, s63
    s_cmp_eq_u32 s50, 23
    s_cselect_b32 s53, 1, s53
    s_branch L_afterP
L_goP1:
    s_mov_b32 m0, s51
    s_waitcnt vmcnt(18)
    buffer_load_dwordx4 v16, s[40:43], s52 offen offset:0 nt lds
    s_waitcnt vmcnt(18)
    buffer_load_dwordx4 v17, s[40:43], s52 offen offset:1024 nt lds
    s_waitcnt vmcnt(18)
    v_mov_b32 v46, s50
    ds_write_b32 v10, v46 offset:32
    buffer_load_dwordx4 v18, s[40:43], s52 offen offset:2048 nt lds
    s_waitcnt vmcnt(18)
    buffer_load_dwordx4 v19, s[40:43], s52 offen offset:3072 nt lds
    s_add_u32 m0, m0, 4096
    s_add_u32 s52, s52, 4096
    s_waitcnt vmcnt(18)
    buffer_load_dwordx4 v20, s[40:43], s52 offen offset:0 nt lds
    s_waitcnt vmcnt(18)
    buffer_load_dwordx4 v21, s[40:43], s52 offen offset:1024 nt lds
    s_waitcnt vmcnt(18)
    buffer_load_dwordx4 v22, s[40:43], s52 offen offset:2048 nt lds
    s_waitcnt vmcnt(18)
    buffer_load_dwordx4 v23, s[40:43], s52 offen offset:3072 nt lds
    s_add_u32 m0, m0, 4096
    s_add_u32 s52, s52, 4096
    s_waitcnt vmcnt(18)
    buffer_load_dwordx4 v16, s[40:43], s52 offen offset:0 nt lds
    s_waitcnt vmcnt(18)
    buffer_load_dwordx4 v17, s[40:43], s52 offen offset:1024 nt lds
    s_waitcnt vmcnt(18)
    buffer_load_dwordx4 v18, s[40:43], s52 offen offset:2048 nt lds
    s_waitcnt vmcnt(18)
    buffer_load_dwordx4 v19, s[40:43], s52 offen offset:3072 nt lds
    s_add_u32 m0, m0, 4096
    s_add_u32 s52, s52, 4096
    ds_read_b128 v[40:43], v10 offset:0
    ds_read_b32 v44, v10 offset:16
    s_waitcnt vmcnt(18)
    buffer_load_dwordx4 v20, s[40:43], s52 offen offset:0 nt lds
    s_waitcnt vmcnt(18)
    buffer_load_dwordx4 v21, s[40:43], s52 offen offset:1024 nt lds
    s_waitcnt vmcnt(18)
    buffer_load_dwordx4 v22, s[40:43], s52 offen offset:2048 nt lds
    s_waitcnt vmcnt(18)
    buffer_load_dwordx4 v23, s[40:43], s52 offen offset:3072 nt lds
    s_add_u32 s52, s52, 4096
    s_add_u32 s51, s51, 16384
    s_cmp_eq_u32 s51, s63
    s_cselect_b32 s51, 0, s51
    s_add_u32 s50, s50, 1
    s_cmp_eq_u32 s50, 18
    s_cselect_b32 s63, 81920, s63
    s_cmp_eq_u32 s50, 23
    s_cselect_b32 s53, 1, s53
    s_branch L_afterP
L_goW1:
    s_mov_b32 m0, s60
    s_waitcnt vmcnt(24)
    buffer_load_dwordx4 v24, s[36:39], s48 offen nt lds
    s_add_u32 m0, m0, 1024
    s_add_u32 s48, s48, 7168
    s_waitcnt vmcnt(24)
    buffer_load_dwordx4 v25, s[36:39], s48 offen nt lds
    s_add_u32 m0, m0, 1024
    s_add_u32 s48, s48, 7168
    s_waitcnt vmcnt(24)
    buffer_load_dwordx4 v24, s[36:39], s48 offen nt lds
    s_add_u32 m0, m0, 1024
    s_add_u32 s48, s48, 7168
    s_waitcnt vmcnt(24)
    buffer_load_dwordx4 v25, s[36:39], s48 offen nt lds
    s_add_u32 m0, m0, 1024
    s_add_u32 s48, s48, 7168
    s_waitcnt vmcnt(24)
    buffer_load_dwordx4 v24, s[36:39], s48 offen nt lds
    s_add_u32 m0, m0, 1024
    s_add_u32 s48, s48, 7168
    s_waitcnt vmcnt(24)
    buffer_load_dwordx4 v25, s[36:39], s48 offen nt lds
    s_add_u32 m0, m0, 1024
    s_add_u32 s48, s48, 7168
    s_mov_b32 s60, m0
    s_mov_b32 m0, s51
    s_waitcnt vmcnt(24)
    buffer_load_dwordx4 v16, s[40:43], s52 offen offset:0 nt lds
    s_waitcnt vmcnt(24)
    buffer_load_dwordx4 v17, s[40:43], s52 offen offset:1024 nt lds
    s_waitcnt vmcnt(24)
    v_mov_b32 v46, s50
    ds_write_b32 v10, v46 offset:32
    buffer_load_dwordx4 v18, s[40:43], s52 offen offset:2048 nt lds
    s_waitcnt vmcnt(24)
    buffer_load_dwordx4 v19, s[40:43], s52 offen offset:3072 nt lds
    s_add_u32 m0, m0, 4096
    s_add_u32 s52, s52, 4096
    s_waitcnt vmcnt(24)
    buffer_load_dwordx4 v20, s[40:43], s52 offen offset:0 nt lds
    s_waitcnt vmcnt(24)
    buffer_load_dwordx4 v21, s[40:43], s52 offen offset:1024 nt lds
    s_waitcnt vmcnt(24)
    buffer_load_dwordx4 v22, s[40:43], s52 offen offset:2048 nt lds
    s_waitcnt vmcnt(24)
    buffer_load_dwordx4 v23, s[40:43], s52 offen offset:3072 nt lds
    s_add_u32 m0, m0, 4096
    s_add_u32 s52, s52, 4096
    s_waitcnt vmcnt(24)
    buffer_load_dwordx4 v16, s[40:43], s52 offen offset:0 nt lds
    s_waitcnt vmcnt(24)
    buffer_load_dwordx4 v17, s[40:43], s52 offen offset:1024 nt lds
    s_waitcnt vmcnt(24)
    buffer_load_dwordx4 v18, s[40:43], s52 offen offset:2048 nt lds
    s_waitcnt vmcnt(24)
    buffer_load_dwordx4 v19, s[40:43], s52 offen offset:3072 nt lds
    s_add_u32 m0, m0, 4096
    s_add_u32 s52, s52, 4096
    ds_read_b128 v[40:43], v10 offset:0
    ds_read_b32 v44, v10 offset:16
    s_waitcnt vmcnt(24)
    buffer_load_dwordx4 v20, s[40:43], s52 offen offset:0 nt lds
    s_waitcnt vmcnt(24)
    buffer_load_dwordx4 v21, s[40:43], s52 offen offset:1024 nt lds
    s_waitcnt vmcnt(24)
    buffer_load_dwordx4 v22, s[40:43], s52 offen offset:2048 nt lds
    s_waitcnt vmcnt(24)
    buffer_load_dwordx4 v23, s[40:43], s52 offen offset:3072 nt lds
    s_add_u32 s52, s52, 4096
    s_add_u32 s51, s51, 16384
    s_cmp_eq_u32 s51, s63
    s_cselect_b32 s51, 0, s51
    s_add_u32 s50, s50, 1
    s_cmp_eq_u32 s50, 18
    s_cselect_b32 s63, 81920, s63
    s_cmp_eq_u32 s50, 23
    s_cselect_b32 s53, 1, s53
    s_branch L_afterW
L_goP2:
    s_mov_b32 m0, s51
    s_waitcnt vmcnt(19)
    buffer_load_dwordx4 v16, s[40:43], s52 offen offset:0 nt lds
    s_waitcnt vmcnt(19)
    buffer_load_dwordx4 v17, s[40:43], s52 offen offset:1024 nt lds
    s_waitcnt vmcnt(19)
    buffer_load_dwordx4 v18, s[40:43], s52 offen offset:2048 nt lds
    s_waitcnt vmcnt(19)
    v_mov_b32 v46, s50
    ds_write_b32 v10, v46 offset:32
    buffer_load_dwordx4 v19, s[40:43], s52 offen offset:3072 nt lds
    s_add_u32 m0, m0, 4096
    s_add_u32 s52, s52, 4096
    s_waitcnt vmcnt(19)
    buffer_load_dwordx4 v20, s[40:43], s52 offen offset:0 nt lds
    s_waitcnt vmcnt(19)
    buffer_load_dwordx4 v21, s[40:43], s52 offen offset:1024 nt lds
    s_waitcnt vmcnt(19)
    buffer_load_dwordx4 v22, s[40:43], s52 offen offset:2048 nt lds
    s_waitcnt vmcnt(19)
    buffer_load_dwordx4 v23, s[40:43], s52 offen offset:3072 nt lds
    s_add_u32 m0, m0, 4096
    s_add_u32 s52, s52, 4096
    s_waitcnt vmcnt(19)
    buffer_load_dwordx4 v16, s[40:43], s52 offen offset:0 nt lds
    s_waitcnt vmcnt(19)
    buffer_load_dwordx4 v17, s[40:43], s52 offen offset:1024 nt lds
    s_waitcnt vmcnt(19)
    buffer_load_dwordx4 v18, s[40:43], s52 offen offset:2048 nt lds
    s_waitcnt vmcnt(19)
    buffer_load_dwordx4 v19, s[40:43], s52 offen offset:3072 nt lds
    s_add_u32 m0, m0, 4096
    s_add_u32 s52, s52, 4096
    ds_read_b128 v[40:43], v10 offset:0
    ds_read_b32 v44, v10 offset:16
    s_waitcnt vmcnt(19)
    buffer_load_dwordx4 v20, s[40:43], s52 offen offset:0 nt lds
    s_waitcnt vmcnt(19)
    buffer_load_dwordx4 v21, s[40:43], s52 offen offset:1024 nt lds
    s_waitcnt vmcnt(19)
    buffer_load_dwordx4 v22, s[40:43], s52 offen offset:2048 nt lds
    s_waitcnt vmcnt(19)
    buffer_load_dwordx4 v23, s[40:43], s52 offen offset:3072 nt lds
    s_add_u32 s52, s52, 4096
    s_add_u32 s51, s51, 16384
    s_cmp_eq_u32 s51, s63
    s_cselect_b32 s51, 0, s51
    s_add_u32 s50, s50, 1
    s_cmp_eq_u32 s50, 18
    s_cselect_b32 s63, 81920, s63
    s_cmp_eq_u32 s50, 23
    s_cselect_b32 s53, 1, s53
    s_branch L_afterP
L_goW2:
    s_mov_b32 m0, s60
    s_waitcnt vmcnt(25)
    buffer_load_dwordx4 v24, s[36:39], s48 offen nt lds
    s_add_u32 m0, m0, 1024
    s_add_u32 s48, s48, 7168
    s_waitcnt vmcnt(25)
    buffer_load_dwordx4 v25, s[36:39], s48 offen nt lds
    s_add_u32 m0, m0, 1024
    s_add_u32 s48, s48, 7168
    s_waitcnt vmcnt(25)
    buffer_load_dwordx4 v24, s[36:39], s48 offen nt lds
    s_add_u32 m0, m0, 1024
    s_add_u32 s48, s48, 7168
    s_waitcnt vmcnt(25)
    buffer_load_dwordx4 v25, s[36:39], s48 offen nt lds
    s_add_u32 m0, m0, 1024
    s_add_u32 s48, s48, 7168
    s_waitcnt vmcnt(25)
    buffer_load_dwordx4 v24, s[36:39], s48 offen nt lds
    s_add_u32 m0, m0, 1024
    s_add_u32 s48, s48, 7168
    s_waitcnt vmcnt(25)
    buffer_load_dwordx4 v25, s[36:39], s48 offen nt lds
    s_add_u32 m0, m0, 1024
    s_add_u32 s48, s48, 7168
    s_mov_b32 s60, m0
    s_mov_b32 m0, s51
    s_waitcnt vmcnt(25)
    buffer_load_dwordx4 v16, s[40:43], s52 offen offset:0 nt lds
    s_waitcnt vmcnt(25)
    buffer_load_dwordx4 v17, s[40:43], s52 offen offset:1024 nt lds
    s_waitcnt vmcnt(25)
    buffer_load_dwordx4 v18, s[40:43], s52 offen offset:2048 nt lds
    s_waitcnt vmcnt(25)
    v_mov_b32 v46, s50
    ds_write_b32 v10, v46 offset:32
    buffer_load_dwordx4 v19, s[40:43], s52 offen offset:3072 nt lds
    s_add_u32 m0, m0, 4096
    s_add_u32 s52, s52, 4096
    s_waitcnt vmcnt(25)
    buffer_load_dwordx4 v20, s[40:43], s52 offen offset:0 nt lds
    s_waitcnt vmcnt(25)
    buffer_load_dwordx4 v21, s[40:43], s52 offen offset:1024 nt lds
    s_waitcnt vmcnt(25)
    buffer_load_dwordx4 v22, s[40:43], s52 offen offset:2048 nt lds
    s_waitcnt vmcnt(25)
    buffer_load_dwordx4 v23, s[40:43], s52 offen offset:3072 nt lds
    s_add_u32 m0, m0, 4096
    s_add_u32 s52, s52, 4096
    s_waitcnt vmcnt(25)
    buffer_load_dwordx4 v16, s[40:43], s52 offen offset:0 nt lds
    s_waitcnt vmcnt(25)
    buffer_load_dwordx4 v17, s[40:43], s52 offen offset:1024 nt lds
    s_waitcnt vmcnt(25)
    buffer_load_dwordx4 v18, s[40:43], s52 offen offset:2048 nt lds
    s_waitcnt vmcnt(25)
    buffer_load_dwordx4 v19, s[40:43], s52 offen offset:3072 nt lds
    s_add_u32 m0, m0, 4096
    s_add_u32 s52, s52, 4096
    ds_read_b128 v[40:43], v10 offset:0
    ds_read_b32 v44, v10 offset:16
    s_waitcnt vmcnt(25)
    buffer_load_dwordx4 v20, s[40:43], s52 offen offset:0 nt lds
    s_waitcnt vmcnt(25)
    buffer_load_dwordx4 v21, s[40:43], s52 offen offset:1024 nt lds
    s_waitcnt vmcnt(25)
    buffer_load_dwordx4 v22, s[40:43], s52 offen offset:2048 nt lds
    s_waitcnt vmcnt(25)
    buffer_load_dwordx4 v23, s[40:43], s52 offen offset:3072 nt lds
    s_add_u32 s52, s52, 4096
    s_add_u32 s51, s51, 16384
    s_cmp_eq_u32 s51, s63
    s_cselect_b32 s51, 0, s51
    s_add_u32 s50, s50, 1
    s_cmp_eq_u32 s50, 18
    s_cselect_b32 s63, 81920, s63
    s_cmp_eq_u32 s50, 23
    s_cselect_b32 s53, 1, s53
    s_branch L_afterW
L_goP3:
    s_mov_b32 m0, s51
    s_waitcnt vmcnt(20)
    buffer_load_dwordx4 v16, s[40:43], s52 offen offset:0 nt lds
    s_waitcnt vmcnt(20)
    buffer_load_dwordx4 v17, s[40:43], s52 offen offset:1024 nt lds
    s_waitcnt vmcnt(20)
    buffer_load_dwordx4 v18, s[40:43], s52 offen offset:2048 nt lds
    s_waitcnt vmcnt(20)
    buffer_load_dwordx4 v19, s[40:43], s52 offen offset:3072 nt lds
    s_add_u32 m0, m0, 4096
    s_add_u32 s52, s52, 4096
    s_waitcnt vmcnt(20)
    v_mov_b32 v46, s50
    ds_write_b32 v10, v46 offset:32
    buffer_load_dwordx4 v20, s[40:43], s52 offen offset:0 nt lds
    s_waitcnt vmcnt(20)
    buffer_load_dwordx4 v21, s[40:43], s52 offen offset:1024 nt lds
    s_waitcnt vmcnt(20)
    buffer_load_dwordx4 v22, s[40:43], s52 offen offset:2048 nt lds
    s_waitcnt vmcnt(20)
    buffer_load_dwordx4 v23, s[40:43], s52 offen offset:3072 nt lds
    s_add_u32 m0, m0, 4096
    s_add_u32 s52, s52, 4096
    s_waitcnt vmcnt(20)
    buffer_load_dwordx4 v16, s[40:43], s52 offen offset:0 nt lds
    s_waitcnt vmcnt(20)
    buffer_load_dwordx4 v17, s[40:43], s52 offen offset:1024 nt lds
    s_waitcnt vmcnt(20)
    buffer_load_dwordx4 v18, s[40:43], s52 offen offset:2048 nt lds
    s_waitcnt vmcnt(20)
    buffer_load_dwordx4 v19, s[40:43], s52 offen offset:3072 nt lds
    s_add_u32 m0, m0, 4096
    s_add_u32 s52, s52, 4096
    ds_read_b128 v[40:43], v10 offset:0
    ds_read_b32 v44, v10 offset:16
    s_waitcnt vmcnt(20)
    buffer_load_dwordx4 v20, s[40:43], s52 offen offset:0 nt lds
    s_waitcnt vmcnt(20)
    buffer_load_dwordx4 v21, s[40:43], s52 offen offset:1024 nt lds
    s_waitcnt vmcnt(20)
    buffer_load_dwordx4 v22, s[40:43], s52 offen offset:2048 nt lds
    s_waitcnt vmcnt(20)
    buffer_load_dwordx4 v23, s[40:43], s52 offen offset:3072 nt lds
    s_add_u32 s52, s52, 4096
    s_add_u32 s51, s51, 16384
    s_cmp_eq_u32 s51, s63
    s_cselect_b32 s51, 0, s51
    s_add_u32 s50, s50, 1
    s_cmp_eq_u32 s50, 18
    s_cselect_b32 s63, 81920, s63
    s_cmp_eq_u32 s50, 23
    s_cselect_b32 s53, 1, s53
    s_branch L_afterP
L_goW3:
    s_mov_b32 m0, s60
    s_waitcnt vmcnt(26)
    buffer_load_dwordx4 v24, s[36:39], s48 offen nt lds
    s_add_u32 m0, m0, 1024
    s_add_u32 s48, s48, 7168
    s_waitcnt vmcnt(26)
    buffer_load_dwordx4 v25, s[36:39], s48 offen nt lds
    s_add_u32 m0, m0, 1024
    s_add_u32 s48, s48, 7168
    s_waitcnt vmcnt(26)
    buffer_load_dwordx4 v24, s[36:39], s48 offen nt lds
    s_add_u32 m0, m0, 1024
    s_add_u32 s48, s48, 7168
    s_waitcnt vmcnt(26)
    buffer_load_dwordx4 v25, s[36:39], s48 offen nt lds
    s_add_u32 m0, m0, 1024
    s_add_u32 s48, s48, 7168
    s_waitcnt vmcnt(26)
    buffer_load_dwordx4 v24, s[36:39], s48 offen nt lds
    s_add_u32 m0, m0, 1024
    s_add_u32 s48, s48, 7168
    s_waitcnt vmcnt(26)
    buffer_load_dwordx4 v25, s[36:39], s48 offen nt lds
    s_add_u32 m0, m0, 1024
    s_add_u32 s48, s48, 7168
    s_mov_b32 s60, m0
    s_mov_b32 m0, s51
    s_waitcnt vmcnt(26)
    buffer_load_dwordx4 v16, s[40:43], s52 offen offset:0 nt lds
    s_waitcnt vmcnt(26)
    buffer_load_dwordx4 v17, s[40:43], s52 offen offset:1024 nt lds
    s_waitcnt vmcnt(26)
    buffer_load_dwordx4 v18, s[40:43], s52 offen offset:2048 nt lds
    s_waitcnt vmcnt(26)
    buffer_load_dwordx4 v19, s[40:43], s52 offen offset:3072 nt lds
    s_add_u32 m0, m0, 4096
    s_add_u32 s52, s52, 4096
    s_waitcnt vmcnt(26)
    v_mov_b32 v46, s50
    ds_write_b32 v10, v46 offset:32
    buffer_load_dwordx4 v20, s[40:43], s52 offen offset:0 nt lds
    s_waitcnt vmcnt(26)
    buffer_load_dwordx4 v21, s[40:43], s52 offen offset:1024 nt lds
    s_waitcnt vmcnt(26)
    buffer_load_dwordx4 v22, s[40:43], s52 offen offset:2048 nt lds
    s_waitcnt vmcnt(26)
    buffer_load_dwordx4 v23, s[40:43], s52 offen offset:3072 nt lds
    s_add_u32 m0, m0, 4096
    s_add_u32 s52, s52, 4096
    s_waitcnt vmcnt(26)
    buffer_load_dwordx4 v16, s[40:43], s52 offen offset:0 nt lds
    s_waitcnt vmcnt(26)
    buffer_load_dwordx4 v17, s[40:43], s52 offen offset:1024 nt lds
    s_waitcnt vmcnt(26)
    buffer_load_dwordx4 v18, s[40:43], s52 offen offset:2048 nt lds
    s_waitcnt vmcnt(26)
    buffer_load_dwordx4 v19, s[40:43], s52 offen offset:3072 nt lds
    s_add_u32 m0, m0, 4096
    s_add_u32 s52, s52, 4096
    ds_read_b128 v[40:43], v10 offset:0
    ds_read_b32 v44, v10 offset:16
    s_waitcnt vmcnt(26)
    buffer_load_dwordx4 v20, s[40:43], s52 offen offset:0 nt lds
    s_waitcnt vmcnt(26)
    buffer_load_dwordx4 v21, s[40:43], s52 offen offset:1024 nt lds
    s_waitcnt vmcnt(26)
    buffer_load_dwordx4 v22, s[40:43], s52 offen offset:2048 nt lds
    s_waitcnt vmcnt(26)
    buffer_load_dwordx4 v23, s[40:43], s52 offen offset:3072 nt lds
    s_add_u32 s52, s52, 4096
    s_add_u32 s51, s51, 16384
    s_cmp_eq_u32 s51, s63
    s_cselect_b32 s51, 0, s51
    s_add_u32 s50, s50, 1
    s_cmp_eq_u32 s50, 18
    s_cselect_b32 s63, 81920, s63
    s_cmp_eq_u32 s50, 23
    s_cselect_b32 s53, 1, s53
    s_branch L_afterW
L_goP4:
    s_mov_b32 m0, s51
    s_waitcnt vmcnt(21)
    buffer_load_dwordx4 v16, s[40:43], s52 offen offset:0 nt lds
    s_waitcnt vmcnt(21)
    buffer_load_dwordx4 v17, s[40:43], s52 offen offset:1024 nt lds
    s_waitcnt vmcnt(21)
    buffer_load_dwordx4 v18, s[40:43], s52 offen offset:2048 nt lds
    s_waitcnt vmcnt(21)
    buffer_load_dwordx4 v19, s[40:43], s52 offen offset:3072 nt lds
    s_add_u32 m0, m0, 4096
    s_add_u32 s52, s52, 4096
    s_waitcnt vmcnt(21)
    buffer_load_dwordx4 v20, s[40:43], s52 offen offset:0 nt lds
    s_waitcnt vmcnt(21)
    v_mov_b32 v46, s50
    ds_write_b32 v10, v46 offset:32
    buffer_load_dwordx4 v21, s[40:43], s52 offen offset:1024 nt lds
    s_waitcnt vmcnt(21)
    buffer_load_dwordx4 v22, s[40:43], s52 offen offset:2048 nt lds
    s_waitcnt vmcnt(21)
    buffer_load_dwordx4 v23, s[40:43], s52 offen offset:3072 nt lds
    s_add_u32 m0, m0, 4096
    s_add_u32 s52, s52, 4096
    s_waitcnt vmcnt(21)
    buffer_load_dwordx4 v16, s[40:43], s52 offen offset:0 nt lds
    s_waitcnt vmcnt(21)
    buffer_load_dwordx4 v17, s[40:43], s52 offen offset:1024 nt lds
    s_waitcnt vmcnt(21)
    buffer_load_dwordx4 v18, s[40:43], s52 offen offset:2048 nt lds
    s_waitcnt vmcnt(21)
    buffer_load_dwordx4 v19, s[40:43], s52 offen offset:3072 nt lds
    s_add_u32 m0, m0, 4096
    s_add_u32 s52, s52, 4096
    ds_read_b128 v[40:43], v10 offset:0
    ds_read_b32 v44, v10 offset:16
    s_waitcnt vmcnt(21)
    buffer_load_dwordx4 v20, s[40:43], s52 offen offset:0 nt lds
    s_waitcnt vmcnt(21)
    buffer_load_dwordx4 v21, s[40:43], s52 offen offset:1024 nt lds
    s_waitcnt vmcnt(21)
    buffer_load_dwordx4 v22, s[40:43], s52 offen offset:2048 nt lds
    s_waitcnt vmcnt(21)
    buffer_load_dwordx4 v23, s[40:43], s52 offen offset:3072 nt lds
    s_add_u32 s52, s52, 4096
    s_add_u32 s51, s51, 16384
    s_cmp_eq_u32 s51, s63
    s_cselect_b32 s51, 0, s51
    s_add_u32 s50, s50, 1
    s_cmp_eq_u32 s50, 18
    s_cselect_b32 s63, 81920, s63
    s_cmp_eq_u32 s50, 23
    s_cselect_b32 s53, 1, s53
    s_branch L_afterP
L_goW4:
    s_mov_b32 m0, s60
    s_waitcnt vmcnt(27)
    buffer_load_dwordx4 v24, s[36:39], s48 offen nt lds
    s_add_u32 m0, m0, 1024
    s_add_u32 s48, s48, 7168
    s_waitcnt vmcnt(27)
    buffer_load_dwordx4 v25, s[36:39], s48 offen nt lds
    s_add_u32 m0, m0, 1024
    s_add_u32 s48, s48, 7168
    s_waitcnt vmcnt(27)
    buffer_load_dwordx4 v24, s[36:39], s48 offen nt lds
    s_add_u32 m0, m0, 1024
    s_add_u32 s48, s48, 7168
    s_waitcnt vmcnt(27)
    buffer_load_dwordx4 v25, s[36:39], s48 offen nt lds
    s_add_u32 m0, m0, 1024
    s_add_u32 s48, s48, 7168
    s_waitcnt vmcnt(27)
    buffer_load_dwordx4 v24, s[36:39], s48 offen nt lds
    s_add_u32 m0, m0, 1024
    s_add_u32 s48, s48, 7168
    s_waitcnt vmcnt(27)
    buffer_load_dwordx4 v25, s[36:39], s48 offen nt lds
    s_add_u32 m0, m0, 1024
    s_add_u32 s48, s48, 7168
    s_mov_b32 s60, m0
    s_mov_b32 m0, s51
    s_waitcnt vmcnt(27)
    buffer_load_dwordx4 v16, s[40:43], s52 offen offset:0 nt lds
    s_waitcnt vmcnt(27)
    buffer_load_dwordx4 v17, s[40:43], s52 offen offset:1024 nt lds
    s_waitcnt vmcnt(27)
    buffer_load_dwordx4 v18, s[40:43], s52 offen offset:2048 nt lds
    s_waitcnt vmcnt(27)
    buffer_load_dwordx4 v19, s[40:43], s52 offen offset:3072 nt lds
    s_add_u32 m0, m0, 4096
    s_add_u32 s52, s52, 4096
    s_waitcnt vmcnt(27)
    buffer_load_dwordx4 v20, s[40:43], s52 offen offset:0 nt lds
    s_waitcnt vmcnt(27)
    v_mov_b32 v46, s50
    ds_write_b32 v10, v46 offset:32
    buffer_load_dwordx4 v21, s[40:43], s52 offen offset:1024 nt lds
    s_waitcnt vmcnt(27)
    buffer_load_dwordx4 v22, s[40:43], s52 offen offset:2048 nt lds
    s_waitcnt vmcnt(27)
    buffer_load_dwordx4 v23, s[40:43], s52 offen offset:3072 nt lds
    s_add_u32 m0, m0, 4096
    s_add_u32 s52, s52, 4096
    s_waitcnt vmcnt(27)
    buffer_load_dwordx4 v16, s[40:43], s52 offen offset:0 nt lds
    s_waitcnt vmcnt(27)
    buffer_load_dwordx4 v17, s[40:43], s52 offen offset:1024 nt lds
    s_waitcnt vmcnt(27)
    buffer_load_dwordx4 v18, s[40:43], s52 offen offset:2048 nt lds
    s_waitcnt vmcnt(27)
    buffer_load_dwordx4 v19, s[40:43], s52 offen offset:3072 nt lds
    s_add_u32 m0, m0, 4096
    s_add_u32 s52, s52, 4096
    ds_read_b128 v[40:43], v10 offset:0
    ds_read_b32 v44, v10 offset:16
    s_waitcnt vmcnt(27)
    buffer_load_dwordx4 v20, s[40:43], s52 offen offset:0 nt lds
    s_waitcnt vmcnt(27)
    buffer_load_dwordx4 v21, s[40:43], s52 offen offset:1024 nt lds
    s_waitcnt vmcnt(27)
    buffer_load_dwordx4 v22, s[40:43], s52 offen offset:2048 nt lds
    s_waitcnt vmcnt(27)
    buffer_load_dwordx4 v23, s[40:43], s52 offen offset:3072 nt lds
    s_add_u32 s52, s52, 4096
    s_add_u32 s51, s51, 16384
    s_cmp_eq_u32 s51, s63
    s_cselect_b32 s51, 0, s51
    s_add_u32 s50, s50, 1
    s_cmp_eq_u32 s50, 18
    s_cselect_b32 s63, 81920, s63
    s_cmp_eq_u32 s50, 23
    s_cselect_b32 s53, 1, s53
    s_branch L_afterW
L_C:
    s_lshl_b32 s50, s3, 2
    v_add_u32 v12, s50, v10
    v_mov_b32 v13, 1
    v_mov_b32 v81, s33
    v_mov_b32 v83, s33
    s_sub_u32 s50, s35, 1
    s_cmp_ge_u32 s50, 3
    s_cbranch_scc1 L_C_noproj
    v_lshrrev_b32 v16, 2, v14
    v_lshl_add_u32 v16, v15, 3, v16
    v_lshlrev_b32 v16, 7, v16
    v_and_b32 v17, 1, v14
    v_lshl_add_u32 v16, v17, 3, v16
    v_and_b32 v17, 1, v15
    v_lshrrev_b32 v18, 3, v14
    v_lshl_add_u32 v17, v17, 1, v18
    v_lshlrev_b32 v17, 1, v17
    v_bfe_u32 v18, v14, 1, 1
    v_xor_b32 v17, v17, v18
    s_lshl_b32 s50, s3, 1
    v_xor_b32 v17, s50, v17
    v_lshl_add_u32 v38, v17, 4, v16
    v_add_u32 v38, 98304, v38
    v_and_b32 v17, 3, v14
    s_movk_i32 s50, 896
    v_mul_u32_u24 v16, s50, v17
    v_lshl_add_u32 v39, v15, 4, v16
    v_add_u32 v39, 155904, v39
    s_lshl_b32 s50, s49, 4
    s_lshl_b32 s52, s3, 2
    s_add_u32 s50, s50, s52
    s_add_u32 s50, s50, 256
    s_lshr_b32 s51, s49, 1
    s_lshl_b32 s51, s51, 1
    s_add_u32 s51, s51, s35
    s_sub_u32 s51, s51, 2
    s_lshl_b32 s51, s51, 3
    s_and_b32 s52, s49, 1
    s_lshl_b32 s52, s52, 2
    s_add_u32 s51, s51, s52
    s_add_u32 s51, s51, s3
    s_lshl_b32 s51, s51, 4
    s_add_u32 s51, s51, 8192
    s_cmp_eq_u32 s35, 1
    s_cselect_b32 s50, s50, s51
    s_cselect_b32 s51, 1024, 4
    v_mad_u32_u24 v16, v14, s51, v15
    v_add_u32 v16, s50, v16
    v_lshlrev_b32 v37, 4, v16
    s_waitcnt vmcnt(0)
    v_lshlrev_b32 v16, 16, v4
    v_and_b32 v17, 0xffff0000, v4
    v_lshlrev_b32 v18, 16, v5
    v_and_b32 v19, 0xffff0000, v5
    v_lshlrev_b32 v20, 16, v6
    v_and_b32 v21, 0xffff0000, v6
    v_lshlrev_b32 v22, 16, v7
    v_and_b32 v23, 0xffff0000, v7
    v_add_f32 v24, v16, v17
    v_add_f32 v25, v18, v19
    v_add_f32 v26, v20, v21
    v_add_f32 v27, v22, v23
    v_add_f32 v24, v24, v25
    v_add_f32 v26, v26, v27
    v_add_f32 v24, v24, v26
    s_nop 1
    v_add_f32_dpp v24, v24, v24 quad_perm:[1,0,3,2] row_mask:0xf bank_mask:0xf
    s_nop 1
    v_add_f32_dpp v24, v24, v24 quad_perm:[2,3,0,1] row_mask:0xf bank_mask:0xf
    s_nop 1
    v_add_f32_dpp v24, v24, v24 row_half_mirror row_mask:0xf bank_mask:0xf
    s_nop 1
    v_add_f32_dpp v24, v24, v24 row_mirror row_mask:0xf bank_mask:0xf
    v_mov_b32 v25, v24
    s_nop 1
    v_permlane16_swap_b32 v24, v25
    v_add_f32 v24, v24, v25
    v_mov_b32 v25, v24
    s_nop 1
    v_permlane32_swap_b32 v24, v25
    v_add_f32 v24, v24, v25
    v_mul_f32 v24, 0x3b124925, v24
    v_mov_b32 v26, 0
    s_mov_b32 exec_hi, 0x00ffffff
    v_sub_f32 v28, v16, v24
    v_sub_f32 v29, v17, v24
    v_sub_f32 v30, v18, v24
    v_sub_f32 v31, v19, v24
    v_sub_f32 v32, v20, v24
    v_sub_f32 v33, v21, v24
    v_sub_f32 v34, v22, v24
    v_sub_f32 v35, v23, v24
    v_fmac_f32 v26, v28, v28
    v_fmac_f32 v26, v29, v29
    v_fmac_f32 v26, v30, v30
    v_fmac_f32 v26, v31, v31
    v_fmac_f32 v26, v32, v32
    v_fmac_f32 v26, v33, v33
    v_fmac_f32 v26, v34, v34
    v_fmac_f32 v26, v35, v35
    s_mov_b32 exec_hi, -1
    v_cvt_pk_bf16_f32 v25, v24, v24
    v_and_b32 v25, 0xffff0000, v25
    v_add_f32_dpp v26, v26, v26 quad_perm:[1,0,3,2] row_mask:0xf bank_mask:0xf
    s_nop 1
    v_add_f32_dpp v26, v26, v26 quad_perm:[2,3,0,1] row_mask:0xf bank_mask:0xf
    s_nop 1
    v_add_f32_dpp v26, v26, v26 row_half_mirror row_mask:0xf bank_mask:0xf
    s_nop 1
    v_add_f32_dpp v26, v26, v26 row_mirror row_mask:0xf bank_mask:0xf
    v_mov_b32 v27, v26
    s_nop 1
    v_permlane16_swap_b32 v26, v27
    v_add_f32 v26, v26, v27
    v_mov_b32 v27, v26
    s_nop 1
    v_permlane32_swap_b32 v26, v27
    v_add_f32 v26, v26, v27
    v_mul_f32 v26, 0x3b124925, v26
    v_cvt_pk_bf16_f32 v26, v26, v26
    v_and_b32 v26, 0xffff0000, v26
    v_add_f32 v26, 0x3727c5ac, v26
    v_cvt_pk_bf16_f32 v26, v26, v26
    v_and_b32 v26, 0xffff0000, v26
    v_sqrt_f32 v26, v26
    v_sub_f32 v28, v16, v25
    v_sub_f32 v29, v17, v25
    v_sub_f32 v30, v18, v25
    v_sub_f32 v31, v19, v25
    v_sub_f32 v32, v20, v25
    v_sub_f32 v33, v21, v25
    v_sub_f32 v34, v22, v25
    v_sub_f32 v35, v23, v25
    v_cvt_pk_bf16_f32 v26, v26, v26
    v_and_b32 v26, 0xffff0000, v26
    v_rcp_f32 v26, v26
    v_cvt_pk_bf16_f32 v16, v28, v29
    v_cvt_pk_bf16_f32 v17, v30, v31
    v_cvt_pk_bf16_f32 v18, v32, v33
    v_cvt_pk_bf16_f32 v19, v34, v35
    v_lshlrev_b32 v28, 16, v16
    v_and_b32 v29, 0xffff0000, v16
    v_lshlrev_b32 v30, 16, v17
    v_and_b32 v31, 0xffff0000, v17
    v_lshlrev_b32 v32, 16, v18
    v_and_b32 v33, 0xffff0000, v18
    v_lshlrev_b32 v34, 16, v19
    v_and_b32 v35, 0xffff0000, v19
    v_mul_f32 v28, v28, v26
    v_mul_f32 v29, v29, v26
    v_mul_f32 v30, v30, v26
    v_mul_f32 v31, v31, v26
    v_mul_f32 v32, v32, v26
    v_mul_f32 v33, v33, v26
    v_mul_f32 v34, v34, v26
    v_mul_f32 v35, v35, v26
    v_cvt_pk_bf16_f32 v16, v28, v29
    v_cvt_pk_bf16_f32 v17, v30, v31
    v_cvt_pk_bf16_f32 v18, v32, v33
    v_cvt_pk_bf16_f32 v19, v34, v35
    v_add_u32 v11, 155904, v11
    s_mov_b32 exec_hi, 0x00ffffff
    ds_write_b128 v11, v[16:19]
    s_mov_b32 exec_hi, -1
    ds_write_b32 v12, v13 offset:48
L_spin4_1:
    ds_read_b128 v[40:43], v10 offset:48
    s_waitcnt lgkmcnt(0)
    v_min_u32 v40, v40, v41
    v_min3_u32 v40, v40, v42, v43
    v_cmp_ne_u32 vcc, 0, v40
    s_cbranch_vccnz L_spin4d_2
    s_sub_u32 s62, s62, 1
    s_cbranch_scc0 L_spin4_1
    s_branch L_fail
L_spin4d_2:
    ds_read_b128 v[84:87], v39 offset:0
    ds_read_b128 v[88:91], v39 offset:64
    ds_read_b128 v[92:95], v39 offset:128
    ds_read_b128 v[96:99], v39 offset:192
    ds_read_b128 v[100:103], v39 offset:256
    ds_read_b128 v[104:107], v39 offset:320
    ds_read_b128 v[108:111], v39 offset:384
    ds_read_b128 v[112:115], v39 offset:448
    ds_read_b128 v[116:119], v39 offset:512
    ds_read_b128 v[120:123], v39 offset:576
    ds_read_b128 v[124:127], v39 offset:640
    ds_read_b128 v[128:131], v39 offset:704
    ds_read_b128 v[132:135], v39 offset:768
    ds_read_b128 v[136:139], v39 offset:832
L_spin_3:
    ds_read_b32 v16, v10 offset:32
    s_waitcnt lgkmcnt(0)
    v_cmp_le_u32 vcc, 1, v16
    s_cbranch_vccnz L_spind_4
    s_sub_u32 s62, s62, 1
    s_cbranch_scc0 L_spin_3
    s_branch L_fail
L_spind_4:
    ds_read_b64_tr_b16 v[140:141], v38 offset:0
    ds_read_b64_tr_b16 v[142:143], v38 offset:512
    ds_read_b64_tr_b16 v[144:145], v38 offset:4096
    ds_read_b64_tr_b16 v[146:147], v38 offset:4608
    ds_read_b64_tr_b16 v[148:149], v38 offset:8192
    ds_read_b64_tr_b16 v[150:151], v38 offset:8704
    ds_read_b64_tr_b16 v[152:153], v38 offset:12288
    ds_read_b64_tr_b16 v[154:155], v38 offset:12800
    ds_read_b64_tr_b16 v[156:157], v38 offset:16384
    ds_read_b64_tr_b16 v[158:159], v38 offset:16896
    ds_read_b64_tr_b16 v[160:161], v38 offset:20480
    ds_read_b64_tr_b16 v[162:163], v38 offset:20992
    ds_read_b64_tr_b16 v[164:165], v38 offset:24576
    ds_read_b64_tr_b16 v[166:167], v38 offset:25088
    ds_read_b64_tr_b16 v[168:169], v38 offset:28672
    ds_read_b64_tr_b16 v[170:171], v38 offset:29184
    ds_read_b64_tr_b16 v[172:173], v38 offset:32768
    ds_read_b64_tr_b16 v[174:175], v38 offset:33280
    ds_read_b64_tr_b16 v[176:177], v38 offset:36864
    ds_read_b64_tr_b16 v[178:179], v38 offset:37376
    ds_read_b64_tr_b16 v[180:181], v38 offset:40960
    ds_read_b64_tr_b16 v[182:183], v38 offset:41472
    ds_read_b64_tr_b16 v[184:185], v38 offset:45056
    ds_read_b64_tr_b16 v[186:187], v38 offset:45568
    ds_read_b64_tr_b16 v[188:189], v38 offset:49152
    ds_read_b64_tr_b16 v[190:191], v38 offset:49664
    ds_read_b64_tr_b16 v[192:193], v38 offset:53248
    ds_read_b64_tr_b16 v[194:195], v38 offset:53760
    s_waitcnt lgkmcnt(14)
    v_mfma_f32_16x16x32_bf16 v[48:51], v[140:143], v[84:87], 0
    v_mfma_f32_16x16x32_bf16 v[48:51], v[144:147], v[88:91], v[48:51]
    v_mfma_f32_16x16x32_bf16 v[48:51], v[148:151], v[92:95], v[48:51]
    v_mfma_f32_16x16x32_bf16 v[48:51], v[152:155], v[96:99], v[48:51]
    v_mfma_f32_16x16x32_bf16 v[48:51], v[156:159], v[100:103], v[48:51]
    v_mfma_f32_16x16x32_bf16 v[48:51], v[160:163], v[104:107], v[48:51]
    s_waitcnt lgkmcnt(12)
    v_mfma_f32_16x16x32_bf16 v[48:51], v[164:167], v[108:111], v[48:51]
    v_mfma_f32_16x16x32_bf16 v[48:51], v[168:171], v[112:115], v[48:51]
    s_waitcnt lgkmcnt(8)
    v_mfma_f32_16x16x32_bf16 v[48:51], v[172:175], v[116:119], v[48:51]
    v_mfma_f32_16x16x32_bf16 v[48:51], v[176:179], v[120:123], v[48:51]
    s_waitcnt lgkmcnt(4)
    v_mfma_f32_16x16x32_bf16 v[48:51], v[180:183], v[124:127], v[48:51]
    v_mfma_f32_16x16x32_bf16 v[48:51], v[184:187], v[128:131], v[48:51]
    s_waitcnt lgkmcnt(0)
    v_mfma_f32_16x16x32_bf16 v[48:51], v[188:191], v[132:135], v[48:51]
    s_waitcnt lgkmcnt(0)
    v_mfma_f32_16x16x32_bf16 v[48:51], v[192:195], v[136:139], v[48:51]
    s_add_u32 s50, s3, 4
    v_mov_b32 v16, s50
    ds_write_b32 v12, v16 offset:0
    s_mov_b32 s50, 0x000f000f
    s_nop 3
    v_cvt_pk_bf16_f32 v80, v48, v49
    v_cvt_pk_bf16_f32 v82, v50, v51
    s_mov_b32 exec_lo, s50
    s_mov_b32 exec_hi, s50
    s_cmp_eq_u32 s35, 1
    s_cbranch_scc1 L_pub_q
    global_store_dwordx4 v37, v[80:83], s[30:31] sc1
    s_branch L_pub_done
L_pub_q:
    global_store_dwordx4 v37, v[80:83], s[30:31]
L_pub_done:
    s_mov_b64 exec, -1
L_C_noproj:
    v_xor_b32 v16, v15, v14
    v_lshlrev_b32 v17, 9, v14
    v_lshl_add_u32 v20, v16, 4, v17
    v_xor_b32 v21, 4, v16
    v_lshl_add_u32 v21, v21, 4, v17
    v_xor_b32 v22, 8, v16
    v_lshl_add_u32 v22, v22, 4, v17
    v_xor_b32 v23, 12, v16
    v_lshl_add_u32 v23, v23, 4, v17
    v_lshrrev_b32 v16, 2, v14
    v_lshl_add_u32 v17, v15, 3, v16
    v_lshlrev_b32 v17, 9, v17
    v_and_b32 v18, 1, v14
    v_lshl_add_u32 v17, v18, 3, v17
    v_and_b32 v18, 1, v15
    v_lshl_add_u32 v18, v18, 2, v16
    v_lshlrev_b32 v18, 1, v18
    v_bfe_u32 v19, v14, 1, 1
    s_lshl_b32 s50, s3, 3
    v_add_u32 v19, s50, v19
    v_xor_b32 v18, v18, v19
    v_lshl_add_u32 v24, v18, 4, v17
    v_xor_b32 v25, 2, v18
    v_lshl_add_u32 v25, v25, 4, v17
    v_xor_b32 v26, 4, v18
    v_lshl_add_u32 v26, v26, 4, v17
    v_xor_b32 v27, 6, v18
    v_lshl_add_u32 v27, v27, 4, v17
    v_and_b32 v16, 1, v0
    v_lshlrev_b32 v17, 4, v15
    v_lshl_add_u32 v28, v16, 9, v17
    v_add_u32 v28, 159488, v28
    v_lshl_add_u32 v29, v16, 10, v17
    v_add_u32 v29, 160512, v29
    v_lshrrev_b32 v16, 5, v0
    v_and_b32 v17, 31, v0
    s_lshl_b32 s50, s3, 5
    v_add_u32 v17, s50, v17
    v_lshlrev_b32 v17, 1, v17
    v_lshl_add_u32 v30, v16, 10, v17
    v_add_u32 v30, 160512, v30
    v_lshl_add_u32 v31, v16, 4, v10
    v_lshl_add_u32 v33, v16, 2, v10
    s_lshl_b32 s50, s3, 2
    v_add_u32 v32, s50, v31
    v_lshrrev_b32 v16, 2, v14
    v_lshl_add_u32 v16, v15, 3, v16
    v_lshlrev_b32 v16, 7, v16
    v_and_b32 v17, 1, v14
    v_lshl_add_u32 v16, v17, 3, v16
    v_and_b32 v17, 1, v15
    v_lshrrev_b32 v18, 3, v14
    v_lshl_add_u32 v17, v17, 1, v18
    v_lshlrev_b32 v17, 1, v17
    v_bfe_u32 v18, v14, 1, 1
    v_xor_b32 v17, v17, v18
    s_lshl_b32 s50, s3, 1
    v_xor_b32 v17, s50, v17
    v_lshl_add_u32 v34, v17, 4, v16
    v_add_u32 v34, 81920, v34
    s_lshl_b32 s50, s6, 3
    s_add_u32 s50, s50, s4
    s_lshl_b32 s50, s50, 15
    s_lshl_b32 s51, s3, 10
    s_add_u32 s50, s50, s51
    s_add_u32 s50, s50, 1048576
    v_add_u32 v16, s50, v9
    s_lshl_b32 s51, s7, 12
    v_add_u32 v35, s51, v16
    s_add_u32 s51, s7, 1
    s_and_b32 s51, s51, 7
    s_lshl_b32 s51, s51, 12
    v_add_u32 v248, s51, v16
    s_add_u32 s51, s7, 2
    s_and_b32 s51, s51, 7
    s_lshl_b32 s51, s51, 12
    v_add_u32 v249, s51, v16
    s_add_u32 s51, s7, 3
    s_and_b32 s51, s51, 7
    s_lshl_b32 s51, s51, 12
    v_add_u32 v250, s51, v16
    s_add_u32 s51, s7, 4
    s_and_b32 s51, s51, 7
    s_lshl_b32 s51, s51, 12
    v_add_u32 v251, s51, v16
    s_add_u32 s51, s7, 5
    s_and_b32 s51, s51, 7
    s_lshl_b32 s51, s51, 12
    v_add_u32 v252, s51, v16
    s_add_u32 s51, s7, 6
    s_and_b32 s51, s51, 7
    s_lshl_b32 s51, s51, 12
    v_add_u32 v253, s51, v16
    s_add_u32 s51, s7, 7
    s_and_b32 s51, s51, 7
    s_lshl_b32 s51, s51, 12
    v_add_u32 v254, s51, v16
    v_lshrrev_b32 v16, 5, v0
    v_lshlrev_b32 v16, 8, v16
    v_and_b32 v17, 1, v15
    v_lshl_add_u32 v16, v17, 5, v16
    v_add_u32 v16, v16, v14
    s_lshl_b32 s50, s3, 6
    v_add_u32 v16, s50, v16
    v_lshlrev_b32 v16, 1, v16
    v_add_u32 v38, 155904, v16
    v_lshlrev_b32 v36, 4, v15
    v_add_u32 v36, 155904, v36
    s_mul_i32 s50, s6, 28
    s_lshl_b32 s51, s7, 2
    s_add_u32 s50, s50, s51
    s_add_u32 s50, s50, s3
    s_lshl_b32 s50, s50, 3
    s_add_u32 s50, s50, s4
    s_lshl_b32 s50, s50, 7
    s_add_u32 s50, s50, 2097152
    v_add_u32 v37, s50, v9
    s_mov_b32 s44, 0xffff0000
    s_mov_b32 s45, 0xffff0000
    s_mov_b32 s46, 0
    s_mov_b32 s47, -1
L_spin_5:
    ds_read_b32 v16, v10 offset:64
    s_waitcnt lgkmcnt(0)
    v_cmp_le_u32 vcc, 1, v16
    s_cbranch_vccnz L_spind_6
    s_sleep 1
    s_sub_u32 s62, s62, 1
    s_cbranch_scc0 L_spin_5
    s_branch L_fail
L_spind_6:
    ds_read_b128 v[64:67], v28 offset:0
    ds_read_b128 v[68:71], v28 offset:64
    ds_read_b128 v[72:75], v28 offset:128
    ds_read_b128 v[76:79], v28 offset:192
    ds_read_b128 v[84:87], v28 offset:256
    ds_read_b128 v[88:91], v28 offset:320
    ds_read_b128 v[92:95], v28 offset:384
    ds_read_b128 v[96:99], v28 offset:448
    s_mov_b32 s50, s3
L_kitem:
    s_add_u32 s51, s50, 2
    s_sub_u32 s52, s50, 9
    s_cmp_ge_u32 s50, 9
    s_cselect_b32 s52, s52, s50
    s_lshl_b32 s52, s52, 14
    v_add_u32 v40, s52, v20
    v_add_u32 v41, s52, v21
    v_add_u32 v42, s52, v22
    v_add_u32 v43, s52, v23
L_spin_7:
    ds_read_b32 v16, v10 offset:32
    s_waitcnt lgkmcnt(0)
    v_cmp_le_u32 vcc, s51, v16
    s_cbranch_vccnz L_spind_8
    s_sleep 1
    s_sub_u32 s62, s62, 1
    s_cbranch_scc0 L_spin_7
    s_branch L_fail
L_spind_8:
    ds_read_b128 v[100:103], v40 offset:0
    ds_read_b128 v[104:107], v40 offset:8192
    ds_read_b128 v[108:111], v41 offset:0
    ds_read_b128 v[112:115], v41 offset:8192
    ds_read_b128 v[116:119], v42 offset:0
    ds_read_b128 v[120:123], v42 offset:8192
    ds_read_b128 v[124:127], v43 offset:0
    ds_read_b128 v[128:131], v43 offset:8192
    ds_read_b128 v[132:135], v40 offset:256
    ds_read_b128 v[136:139], v40 offset:8448
    ds_read_b128 v[140:143], v41 offset:256
    ds_read_b128 v[144:147], v41 offset:8448
    ds_read_b128 v[148:151], v42 offset:256
    ds_read_b128 v[152:155], v42 offset:8448
    ds_read_b128 v[156:159], v43 offset:256
    ds_read_b128 v[160:163], v43 offset:8448
    s_add_u32 s51, s50, 4
    s_min_u32 s51, s51, 16
    s_add_u32 s51, s51, 4
    v_mov_b32 v16, s51
    ds_write_b32 v12, v16 offset:0
    v_mov_b32 v63, v62
    v_mov_b32 v62, v61
    v_mov_b32 v61, v60
    s_waitcnt lgkmcnt(13)
    v_mfma_f32_16x16x32_bf16 v[48:51], v[64:67], v[100:103], 0
    v_mfma_f32_16x16x32_bf16 v[52:55], v[64:67], v[104:107], 0
    v_mfma_f32_16x16x32_bf16 v[48:51], v[68:71], v[108:111], v[48:51]
    v_mfma_f32_16x16x32_bf16 v[52:55], v[68:71], v[112:115], v[52:55]
    s_waitcnt lgkmcnt(9)
    v_mfma_f32_16x16x32_bf16 v[48:51], v[72:75], v[116:119], v[48:51]
    v_mfma_f32_16x16x32_bf16 v[52:55], v[72:75], v[120:123], v[52:55]
    v_mfma_f32_16x16x32_bf16 v[48:51], v[76:79], v[124:127], v[48:51]
    v_mfma_f32_16x16x32_bf16 v[52:55], v[76:79], v[128:131], v[52:55]
    s_waitcnt lgkmcnt(5)
    v_mfma_f32_16x16x32_bf16 v[48:51], v[84:87], v[132:135], v[48:51]
    v_mfma_f32_16x16x32_bf16 v[52:55], v[84:87], v[136:139], v[52:55]
    v_mfma_f32_16x16x32_bf16 v[48:51], v[88:91], v[140:143], v[48:51]
    v_mfma_f32_16x16x32_bf16 v[52:55], v[88:91], v[144:147], v[52:55]
    s_waitcnt lgkmcnt(1)
    v_mfma_f32_16x16x32_bf16 v[48:51], v[92:95], v[148:151], v[48:51]
    v_mfma_f32_16x16x32_bf16 v[52:55], v[92:95], v[152:155], v[52:55]
    v_mfma_f32_16x16x32_bf16 v[48:51], v[96:99], v[156:159], v[48:51]
    v_mfma_f32_16x16x32_bf16 v[52:55], v[96:99], v[160:163], v[52:55]
    s_nop 7
    v_cndmask_b32 v16, v48, v52, s[44:45]
    v_cndmask_b32 v17, v49, v53, s[44:45]
    v_cndmask_b32 v16, v16, v17, s[46:47]
    v_cvt_pk_bf16_f32 v60, v16, v16
    v_and_b32 v60, 0xffff0000, v60
    s_add_u32 s50, s50, 4
    s_cmp_lt_u32 s50, 16
    s_cbranch_scc1 L_kitem
    v_max_f32 v16, v60, v61
    v_max3_f32 v16, v16, v62, v63
    s_nop 1
    v_max_f32_dpp v16, v16, v16 quad_perm:[1,0,3,2] row_mask:0xf bank_mask:0xf
    s_nop 1
    v_max_f32_dpp v16, v16, v16 quad_perm:[2,3,0,1] row_mask:0xf bank_mask:0xf
    s_nop 1
    v_max_f32_dpp v16, v16, v16 row_half_mirror row_mask:0xf bank_mask:0xf
    s_nop 1
    v_max_f32_dpp v16, v16, v16 row_mirror row_mask:0xf bank_mask:0xf
    v_mov_b32 v17, v16
    s_nop 1
    v_permlane16_swap_b32 v16, v17
    v_max_f32 v16, v16, v17
    ds_write_b32 v32, v16 offset:128
    ds_write_b32 v12, v13 offset:80
L_spin4_9:
    ds_read_b128 v[40:43], v10 offset:80
    s_waitcnt lgkmcnt(0)
    v_min_u32 v40, v40, v41
    v_min3_u32 v40, v40, v42, v43
    v_cmp_ne_u32 vcc, 0, v40
    s_cbranch_vccnz L_spin4d_10
    s_sub_u32 s62, s62, 1
    s_cbranch_scc0 L_spin4_9
    s_branch L_fail
L_spin4d_10:
    ds_read_b128 v[40:43], v31 offset:128
    s_waitcnt lgkmcnt(0)
    v_max_f32 v16, v40, v41
    v_max3_f32 v16, v16, v42, v43
    s_mov_b32 s50, 0x3db8aa3b
    v_sub_f32 v60, v60, v16
    v_sub_f32 v61, v61, v16
    v_sub_f32 v62, v62, v16
    v_sub_f32 v63, v63, v16
    v_mul_f32 v60, s50, v60
    v_mul_f32 v61, s50, v61
    v_mul_f32 v62, s50, v62
    v_mul_f32 v63, s50, v63
    v_exp_f32 v60, v60
    v_exp_f32 v61, v61
    v_exp_f32 v62, v62
    v_exp_f32 v63, v63
    v_add_f32 v17, v60, v61
    v_add_f32 v18, v62, v63
    v_add_f32 v17, v17, v18
    s_nop 1
    v_add_f32_dpp v17, v17, v17 quad_perm:[1,0,3,2] row_mask:0xf bank_mask:0xf
    s_nop 1
    v_add_f32_dpp v17, v17, v17 quad_perm:[2,3,0,1] row_mask:0xf bank_mask:0xf
    s_nop 1
    v_add_f32_dpp v17, v17, v17 row_half_mirror row_mask:0xf bank_mask:0xf
    s_nop 1
    v_add_f32_dpp v17, v17, v17 row_mirror row_mask:0xf bank_mask:0xf
    v_mov_b32 v18, v17
    s_nop 1
    v_permlane16_swap_b32 v17, v18
    v_add_f32 v17, v17, v18
    ds_write_b32 v32, v17 offset:160
    ds_write_b32 v12, v13 offset:96
    v_mov_b32 v64, 0
    v_mov_b32 v65, 0
    v_mov_b32 v66, 0
    v_mov_b32 v67, 0
    v_mov_b32 v68, 0
    v_mov_b32 v69, 0
    v_mov_b32 v70, 0
    v_mov_b32 v71, 0
    v_mov_b32 v72, 0
    v_mov_b32 v73, 0
    v_mov_b32 v74, 0
    v_mov_b32 v75, 0
    v_mov_b32 v76, 0
    v_mov_b32 v77, 0
    v_mov_b32 v78, 0
    v_mov_b32 v79, 0
L_spin_11:
    ds_read_b32 v16, v10 offset:112
    s_waitcnt lgkmcnt(0)
    v_cmp_le_u32 vcc, 1, v16
    s_cbranch_vccnz L_spind_12
    s_sleep 1
    s_sub_u32 s62, s62, 1
    s_cbranch_scc0 L_spin_11
    s_branch L_fail
L_spind_12:
    ds_read_b32 v39, v33 offset:192
    ds_read_b32 v16, v10 offset:200
    s_waitcnt lgkmcnt(0)
    v_readfirstlane_b32 s57, v16
    v_mul_f32 v60, v60, v39
    v_mul_f32 v61, v61, v39
    v_mul_f32 v62, v62, v39
    v_mul_f32 v63, v63, v39
    v_cvt_pk_bf16_f32 v40, v63, v62
    v_cvt_pk_bf16_f32 v41, v61, v60
    ds_write_b16 v30, v40 offset:0
    ds_write_b16_d16_hi v30, v40 offset:256
    ds_write_b16 v30, v41 offset:512
    ds_write_b16_d16_hi v30, v41 offset:768
    ds_write_b32 v12, v13 offset:208
L_spin4_13:
    ds_read_b128 v[40:43], v10 offset:208
    s_waitcnt lgkmcnt(0)
    v_min_u32 v40, v40, v41
    v_min3_u32 v40, v40, v42, v43
    v_cmp_ne_u32 vcc, 0, v40
    s_cbranch_vccnz L_spin4d_14
    s_sub_u32 s62, s62, 1
    s_cbranch_scc0 L_spin4_13
    s_branch L_fail
L_spin4d_14:
    s_mov_b32 s50, 0
    s_mov_b32 s52, 114688
L_vitem:
    ds_read_b128 v[44:47], v29
    v_add_u32 v29, 64, v29
    v_add_u32 v40, s52, v24
    v_add_u32 v41, s52, v25
    v_add_u32 v42, s52, v26
    v_add_u32 v43, s52, v27
    s_add_u32 s51, s50, 18
L_spin_15:
    ds_read_b32 v16, v10 offset:32
    s_waitcnt lgkmcnt(0)
    v_cmp_le_u32 vcc, s51, v16
    s_cbranch_vccnz L_spind_16
    s_sub_u32 s62, s62, 1
    s_cbranch_scc0 L_spin_15
    s_branch L_fail
L_spind_16:
    ds_read_b64_tr_b16 v[96:97], v40
    ds_read_b64_tr_b16 v[98:99], v40 offset:2048
    ds_read_b64_tr_b16 v[100:101], v41
    ds_read_b64_tr_b16 v[102:103], v41 offset:2048
    ds_read_b64_tr_b16 v[104:105], v42
    ds_read_b64_tr_b16 v[106:107], v42 offset:2048
    ds_read_b64_tr_b16 v[108:109], v43
    ds_read_b64_tr_b16 v[110:111], v43 offset:2048
    s_add_u32 s51, s50, 21
    v_mov_b32 v16, s51
    ds_write_b32 v12, v16 offset:0
    s_add_u32 s52, s52, 16384
    s_cmp_eq_u32 s52, 81920
    s_cselect_b32 s52, 0, s52
    s_cmp_eq_u32 s52, 147456
    s_cselect_b32 s52, 0, s52
    s_waitcnt lgkmcnt(7)
    v_mfma_f32_16x16x32_bf16 v[64:67], v[44:47], v[96:99], v[64:67]
    s_waitcnt lgkmcnt(5)
    v_mfma_f32_16x16x32_bf16 v[68:71], v[44:47], v[100:103], v[68:71]
    s_waitcnt lgkmcnt(3)
    v_mfma_f32_16x16x32_bf16 v[72:75], v[44:47], v[104:107], v[72:75]
    s_waitcnt lgkmcnt(1)
    v_mfma_f32_16x16x32_bf16 v[76:79], v[44:47], v[108:111], v[76:79]
    s_add_u32 s50, s50, 1
    s_cmp_lt_u32 s50, 14
    s_cbranch_scc1 L_vitem
    s_cmp_eq_u32 s50, 15
    s_cbranch_scc1 L_first
    ds_read_b64_tr_b16 v[150:151], v34 offset:0
    ds_read_b64_tr_b16 v[152:153], v34 offset:512
    ds_read_b64_tr_b16 v[154:155], v34 offset:4096
    ds_read_b64_tr_b16 v[156:157], v34 offset:4608
    ds_read_b64_tr_b16 v[158:159], v34 offset:8192
    ds_read_b64_tr_b16 v[160:161], v34 offset:8704
    ds_read_b64_tr_b16 v[162:163], v34 offset:12288
    ds_read_b64_tr_b16 v[164:165], v34 offset:12800
    ds_read_b64_tr_b16 v[166:167], v34 offset:16384
    ds_read_b64_tr_b16 v[168:169], v34 offset:16896
    ds_read_b64_tr_b16 v[170:171], v34 offset:20480
    ds_read_b64_tr_b16 v[172:173], v34 offset:20992
    ds_read_b64_tr_b16 v[174:175], v34 offset:24576
    ds_read_b64_tr_b16 v[176:177], v34 offset:25088
    ds_read_b64_tr_b16 v[178:179], v34 offset:28672
    ds_read_b64_tr_b16 v[180:181], v34 offset:29184
    ds_read_b64_tr_b16 v[182:183], v34 offset:32768
    ds_read_b64_tr_b16 v[184:185], v34 offset:33280
    ds_read_b64_tr_b16 v[186:187], v34 offset:36864
    ds_read_b64_tr_b16 v[188:189], v34 offset:37376
    ds_read_b64_tr_b16 v[190:191], v34 offset:40960
    ds_read_b64_tr_b16 v[192:193], v34 offset:41472
    ds_read_b64_tr_b16 v[194:195], v34 offset:45056
    ds_read_b64_tr_b16 v[196:197], v34 offset:45568
    ds_read_b64_tr_b16 v[198:199], v34 offset:49152
    ds_read_b64_tr_b16 v[200:201], v34 offset:49664
    ds_read_b64_tr_b16 v[202:203], v34 offset:53248
    ds_read_b64_tr_b16 v[204:205], v34 offset:53760
    ds_read_b64_tr_b16 v[206:207], v34 offset:57344
    ds_read_b64_tr_b16 v[208:209], v34 offset:57856
    ds_read_b64_tr_b16 v[210:211], v34 offset:61440
    ds_read_b64_tr_b16 v[212:213], v34 offset:61952
    s_branch L_vitem
L_first:
    s_cmp_eq_u32 s7, 7
    s_cbranch_scc1 L_last
    global_load_dwordx4 v[120:123], v248, s[30:31] sc1
    global_load_dwordx4 v[124:127], v249, s[30:31] sc1
    global_load_dwordx4 v[128:131], v250, s[30:31] sc1
    global_load_dwordx4 v[132:135], v251, s[30:31] sc1
    global_load_dwordx4 v[136:139], v252, s[30:31] sc1
    global_load_dwordx4 v[140:143], v253, s[30:31] sc1
    global_load_dwordx4 v[144:147], v254, s[30:31] sc1
L_last:
    ds_read_b128 v[44:47], v29
    v_add_u32 v40, s52, v24
    v_add_u32 v41, s52, v25
    v_add_u32 v42, s52, v26
    v_add_u32 v43, s52, v27
L_last_spin:
    ds_read_b32 v16, v10 offset:32
    ds_read_b64_tr_b16 v[96:97], v40
    ds_read_b64_tr_b16 v[98:99], v40 offset:2048
    ds_read_b64_tr_b16 v[100:101], v41
    ds_read_b64_tr_b16 v[102:103], v41 offset:2048
    ds_read_b64_tr_b16 v[104:105], v42
    ds_read_b64_tr_b16 v[106:107], v42 offset:2048
    ds_read_b64_tr_b16 v[108:109], v43
    ds_read_b64_tr_b16 v[110:111], v43 offset:2048
    s_sub_u32 s62, s62, 1
    s_cbranch_scc1 L_fail
    s_waitcnt lgkmcnt(6)
    v_cmp_gt_u32 vcc, 33, v16
    s_cbranch_vccnz L_last_spin
    v_mfma_f32_16x16x32_bf16 v[64:67], v[44:47], v[96:99], v[64:67]
    s_waitcnt lgkmcnt(4)
    v_mfma_f32_16x16x32_bf16 v[68:71], v[44:47], v[100:103], v[68:71]
    s_waitcnt lgkmcnt(2)
    v_mfma_f32_16x16x32_bf16 v[72:75], v[44:47], v[104:107], v[72:75]
    s_waitcnt lgkmcnt(0)
    v_mfma_f32_16x16x32_bf16 v[76:79], v[44:47], v[108:111], v[76:79]
    s_nop 5
    v_cndmask_b32 v16, v64, v72, s[44:45]
    v_cndmask_b32 v17, v65, v73, s[44:45]
    v_cndmask_b32 v18, v68, v76, s[44:45]
    v_cndmask_b32 v19, v69, v77, s[44:45]
    s_cmp_eq_u32 s57, 1
    v_cndmask_b32 v80, v16, v17, s[46:47]
    v_cndmask_b32 v82, v18, v19, s[46:47]
    s_cbranch_scc0 L_st_far
    global_store_dwordx4 v35, v[80:83], s[30:31]
L_st_done:
    s_cmp_eq_u32 s7, 7
    s_cbranch_scc1 L_red
    s_waitcnt vmcnt(1)
L_h1_chk:
    v_cmp_ne_u32 s[68:69], s33, v123
    v_cmp_ne_u32 s[70:71], s33, v127
    v_cmp_ne_u32 s[72:73], s33, v131
    v_cmp_ne_u32 s[74:75], s33, v135
    v_cmp_ne_u32 s[76:77], s33, v139
    v_cmp_ne_u32 s[78:79], s33, v143
    v_cmp_ne_u32 s[80:81], s33, v147
    v_xor_b32 v96, s33, v121
    v_xor_b32 v97, s33, v125
    s_or_b64 vcc, s[68:69], s[70:71]
    s_or_b64 s[82:83], s[72:73], s[74:75]
    s_or_b64 s[84:85], s[76:77], s[78:79]
    v_bitop3_b32 v96, v129, s33, v96 bitop3:0xbe
    v_bitop3_b32 v97, v133, s33, v97 bitop3:0xbe
    s_or_b64 vcc, vcc, s[80:81]
    s_or_b64 s[82:83], s[82:83], s[84:85]
    s_or_b64 vcc, vcc, s[82:83]
    s_cbranch_scc1 L_h1_more
L_h1_ver:
    v_bitop3_b32 v96, v137, s33, v96 bitop3:0xbe
    v_bitop3_b32 v97, v141, s33, v97 bitop3:0xbe
    v_bitop3_b32 v96, v145, s33, v96 bitop3:0xbe
    v_or_b32 v96, v96, v97
    v_cmp_ne_u32 vcc, 0, v96
    s_cbranch_vccnz L_h1_all
    v_add_f32 v56, v80, v120
    v_add_f32 v57, v82, v122
    v_add_f32 v124, v124, v128
    v_add_f32 v126, v126, v130
    v_add_f32 v132, v132, v136
    v_add_f32 v134, v134, v138
    v_add_f32 v140, v140, v144
    v_add_f32 v142, v142, v146
    v_add_f32 v56, v56, v124
    v_add_f32 v57, v57, v126
    v_add_f32 v132, v132, v140
    v_add_f32 v134, v134, v142
    v_add_f32 v56, v56, v132
    v_add_f32 v57, v57, v134
    v_cvt_pk_bf16_f32 v16, v56, v57
    ds_write_b16 v38, v16
    ds_write_b16_d16_hi v38, v16 offset:32
    ds_write_b32 v12, v13 offset:224
L_o_spin:
    ds_read_b128 v[40:43], v10 offset:224
    ds_read_b128 v[84:87], v36 offset:0
    ds_read_b128 v[88:91], v36 offset:64
    ds_read_b128 v[92:95], v36 offset:128
    ds_read_b128 v[96:99], v36 offset:192
    ds_read_b128 v[100:103], v36 offset:256
    ds_read_b128 v[104:107], v36 offset:320
    ds_read_b128 v[108:111], v36 offset:384
    ds_read_b128 v[112:115], v36 offset:448
    s_sub_u32 s62, s62, 1
    s_cbranch_scc1 L_fail
    s_waitcnt lgkmcnt(8)
    v_min_u32 v40, v40, v41
    v_min3_u32 v40, v40, v42, v43
    v_cmp_eq_u32 vcc, 0, v40
    s_cbranch_vccnz L_o_spin
    ds_read_b128 v[116:119], v36 offset:512
    ds_read_b128 v[120:123], v36 offset:576
    ds_read_b128 v[124:127], v36 offset:640
    ds_read_b128 v[128:131], v36 offset:704
    ds_read_b128 v[132:135], v36 offset:768
    ds_read_b128 v[136:139], v36 offset:832
    ds_read_b128 v[140:143], v36 offset:896
    ds_read_b128 v[144:147], v36 offset:960
    s_waitcnt lgkmcnt(12)
    v_mfma_f32_16x16x32_bf16 v[48:51], v[84:87], v[150:153], 0
    v_mfma_f32_16x16x32_bf16 v[52:55], v[88:91], v[154:157], 0
    v_mfma_f32_16x16x32_bf16 v[48:51], v[92:95], v[158:161], v[48:51]
    v_mfma_f32_16x16x32_bf16 v[52:55], v[96:99], v[162:165], v[52:55]
    s_waitcnt lgkmcnt(8)
    v_mfma_f32_16x16x32_bf16 v[48:51], v[100:103], v[166:169], v[48:51]
    v_mfma_f32_16x16x32_bf16 v[52:55], v[104:107], v[170:173], v[52:55]
    v_mfma_f32_16x16x32_bf16 v[48:51], v[108:111], v[174:177], v[48:51]
    v_mfma_f32_16x16x32_bf16 v[52:55], v[112:115], v[178:181], v[52:55]
    s_waitcnt lgkmcnt(4)
    v_mfma_f32_16x16x32_bf16 v[48:51], v[116:119], v[182:185], v[48:51]
    v_mfma_f32_16x16x32_bf16 v[52:55], v[120:123], v[186:189], v[52:55]
    v_mfma_f32_16x16x32_bf16 v[48:51], v[124:127], v[190:193], v[48:51]
    v_mfma_f32_16x16x32_bf16 v[52:55], v[128:131], v[194:197], v[52:55]
    s_waitcnt lgkmcnt(0)
    v_mfma_f32_16x16x32_bf16 v[48:51], v[132:135], v[198:201], v[48:51]
    v_mfma_f32_16x16x32_bf16 v[52:55], v[136:139], v[202:205], v[52:55]
    v_mfma_f32_16x16x32_bf16 v[48:51], v[140:143], v[206:209], v[48:51]
    v_mfma_f32_16x16x32_bf16 v[52:55], v[144:147], v[210:213], v[52:55]
    s_nop 7
    v_add_f32 v80, v48, v52
    s_nop 1
    v_mov_b32_dpp v82, v80 row_ror:8 row_mask:0xf bank_mask:0xf
    s_mov_b64 exec, 0xff
    global_store_dwordx4 v37, v[80:83], s[30:31] sc1
    s_endpgm
L_h1_all:
    s_mov_b64 s[68:69], -1
    s_mov_b64 s[70:71], -1
    s_mov_b64 s[72:73], -1
    s_mov_b64 s[74:75], -1
    s_mov_b64 s[76:77], -1
    s_mov_b64 s[78:79], -1
    s_mov_b64 s[80:81], -1
L_h1_more:
    s_mov_b32 s56, 0
    s_cmp_lg_u64 s[68:69], 0
    s_addc_u32 s56, s56, s56
    s_cmp_lg_u64 s[70:71], 0
    s_addc_u32 s56, s56, s56
    s_cmp_lg_u64 s[72:73], 0
    s_addc_u32 s56, s56, s56
    s_cmp_lg_u64 s[74:75], 0
    s_addc_u32 s56, s56, s56
    s_cmp_lg_u64 s[76:77], 0
    s_addc_u32 s56, s56, s56
    s_cmp_lg_u64 s[78:79], 0
    s_addc_u32 s56, s56, s56
    s_cmp_lg_u64 s[80:81], 0
    s_addc_u32 s56, s56, s56
    s_sub_u32 s55, s56, 1
    s_and_b32 s55, s55, s56
    s_cbranch_scc0 L_h1_one
    s_mov_b64 exec, s[68:69]
    global_load_dwordx4 v[120:123], v248, s[30:31] sc1
    s_mov_b64 exec, s[70:71]
    global_load_dwordx4 v[124:127], v249, s[30:31] sc1
    s_mov_b64 exec, s[72:73]
    global_load_dwordx4 v[128:131], v250, s[30:31] sc1
    s_mov_b64 exec, s[74:75]
    global_load_dwordx4 v[132:135], v251, s[30:31] sc1
    s_mov_b64 exec, s[76:77]
    global_load_dwordx4 v[136:139], v252, s[30:31] sc1
    s_mov_b64 exec, s[78:79]
    global_load_dwordx4 v[140:143], v253, s[30:31] sc1
    s_mov_b64 exec, s[80:81]
    global_load_dwordx4 v[144:147], v254, s[30:31] sc1
    s_mov_b64 exec, -1
    s_sub_u32 s62, s62, 1
    s_cbranch_scc1 L_fail
    s_waitcnt vmcnt(0)
    s_branch L_h1_chk
L_h1_one:
    s_bitcmp1_b32 s56, 6
    s_cbranch_scc1 L_h1_t0
    s_bitcmp1_b32 s56, 5
    s_cbranch_scc1 L_h1_t1
    s_bitcmp1_b32 s56, 4
    s_cbranch_scc1 L_h1_t2
    s_bitcmp1_b32 s56, 3
    s_cbranch_scc1 L_h1_t3
    s_bitcmp1_b32 s56, 2
    s_cbranch_scc1 L_h1_t4
    s_bitcmp1_b32 s56, 1
    s_cbranch_scc1 L_h1_t5
L_h1_t6:
    global_load_dwordx4 v[144:147], v254, s[30:31] sc1
    s_sub_u32 s62, s62, 1
    s_cbranch_scc1 L_fail
    s_waitcnt vmcnt(0)
    v_cmp_ne_u32 vcc, s33, v147
    v_xor_b32 v96, s33, v121
    v_xor_b32 v97, s33, v125
    s_cbranch_vccnz L_h1_t6
    v_bitop3_b32 v96, v129, s33, v96 bitop3:0xbe
    v_bitop3_b32 v97, v133, s33, v97 bitop3:0xbe
    s_branch L_h1_ver
L_h1_t0:
    global_load_dwordx4 v[120:123], v248, s[30:31] sc1
    s_sub_u32 s62, s62, 1
    s_cbranch_scc1 L_fail
    s_waitcnt vmcnt(0)
    v_cmp_ne_u32 vcc, s33, v123
    v_xor_b32 v96, s33, v121
    v_xor_b32 v97, s33, v125
    s_cbranch_vccnz L_h1_t0
    v_bitop3_b32 v96, v129, s33, v96 bitop3:0xbe
    v_bitop3_b32 v97, v133, s33, v97 bitop3:0xbe
    s_branch L_h1_ver
L_h1_t1:
    global_load_dwordx4 v[124:127], v249, s[30:31] sc1
    s_sub_u32 s62, s62, 1
    s_cbranch_scc1 L_fail
    s_waitcnt vmcnt(0)
    v_cmp_ne_u32 vcc, s33, v127
    v_xor_b32 v96, s33, v121
    v_xor_b32 v97, s33, v125
    s_cbranch_vccnz L_h1_t1
    v_bitop3_b32 v96, v129, s33, v96 bitop3:0xbe
    v_bitop3_b32 v97, v133, s33, v97 bitop3:0xbe
    s_branch L_h1_ver
L_h1_t2:
    global_load_dwordx4 v[128:131], v250, s[30:31] sc1
    s_sub_u32 s62, s62, 1
    s_cbranch_scc1 L_fail
    s_waitcnt vmcnt(0)
    v_cmp_ne_u32 vcc, s33, v131
    v_xor_b32 v96, s33, v121
    v_xor_b32 v97, s33, v125
    s_cbranch_vccnz L_h1_t2
    v_bitop3_b32 v96, v129, s33, v96 bitop3:0xbe
    v_bitop3_b32 v97, v133, s33, v97 bitop3:0xbe
    s_branch L_h1_ver
L_h1_t3:
    global_load_dwordx4 v[132:135], v251, s[30:31] sc1
    s_sub_u32 s62, s62, 1
    s_cbranch_scc1 L_fail
    s_waitcnt vmcnt(0)
    v_cmp_ne_u32 vcc, s33, v135
    v_xor_b32 v96, s33, v121
    v_xor_b32 v97, s33, v125
    s_cbranch_vccnz L_h1_t3
    v_bitop3_b32 v96, v129, s33, v96 bitop3:0xbe
    v_bitop3_b32 v97, v133, s33, v97 bitop3:0xbe
    s_branch L_h1_ver
L_h1_t4:
    global_load_dwordx4 v[136:139], v252, s[30:31] sc1
    s_sub_u32 s62, s62, 1
    s_cbranch_scc1 L_fail
    s_waitcnt vmcnt(0)
    v_cmp_ne_u32 vcc, s33, v139
    v_xor_b32 v96, s33, v121
    v_xor_b32 v97, s33, v125
    s_cbranch_vccnz L_h1_t4
    v_bitop3_b32 v96, v129, s33, v96 bitop3:0xbe
    v_bitop3_b32 v97, v133, s33, v97 bitop3:0xbe
    s_branch L_h1_ver
L_h1_t5:
    global_load_dwordx4 v[140:143], v253, s[30:31] sc1
    s_sub_u32 s62, s62, 1
    s_cbranch_scc1 L_fail
    s_waitcnt vmcnt(0)
    v_cmp_ne_u32 vcc, s33, v143
    v_xor_b32 v96, s33, v121
    v_xor_b32 v97, s33, v125
    s_cbranch_vccnz L_h1_t5
    v_bitop3_b32 v96, v129, s33, v96 bitop3:0xbe
    v_bitop3_b32 v97, v133, s33, v97 bitop3:0xbe
    s_branch L_h1_ver
L_st_far:
    global_store_dwordx4 v35, v[80:83], s[30:31] sc1
    s_branch L_st_done
L_red:
    s_cmp_eq_u32 s4, 7
    s_cbranch_scc1 L_exit
    s_lshl_b32 s52, s4, 2
    s_add_u32 s52, s52, s3
    s_mul_i32 s50, s6, 28
    s_add_u32 s50, s50, s52
    s_mul_i32 s53, s6, 448
    s_lshl_b32 s54, s52, 4
    s_add_u32 s53, s53, s54
    v_lshrrev_b32 v16, 5, v0
    v_and_b32 v17, 7, v0
    v_lshl_add_u32 v18, v16, 3, v17
    v_add_u32 v19, s53, v18
    v_lshlrev_b32 v24, 1, v19
    s_mul_i32 s54, s6, 7
    s_add_u32 s53, s4, s54
    s_lshl_b32 s53, s53, 9
    s_lshl_b32 s54, s3, 6
    s_add_u32 s53, s53, s54
    s_add_u32 s53, s53, 262144
    v_bfe_u32 v19, v18, 1, 1
    v_lshlrev_b32 v19, 8, v19
    v_lshrrev_b32 v20, 2, v18
    v_lshl_add_u32 v19, v20, 4, v19
    v_and_b32 v20, 1, v18
    v_lshl_add_u32 v19, v20, 3, v19
    v_add_u32 v19, s53, v19
    v_bfe_u32 v21, v0, 3, 2
    s_movk_i32 s54, 14336
    v_mad_u32_u24 v25, v21, s54, v19
    v_add_u32 v27, 57344, v25
    v_add_u32 v28, 114688, v25
    v_min_u32 v22, 1, v21
    v_add_u32 v22, 12, v22
    v_mad_u32_u24 v29, v22, s54, v19
    v_cmp_gt_u32 s[44:45], 2, v21
    s_lshl_b32 s56, s50, 10
    s_add_u32 s56, s56, 2097152
    v_add_u32 v26, s56, v9
    global_load_ushort v30, v24, s[8:9]
    s_branch L_og_first
L_og_retry:
    s_sub_u32 s62, s62, 1
    s_cbranch_scc1 L_fail
    s_waitcnt vmcnt(0)
L_og_first:
    global_load_dwordx2 v[32:33], v25, s[30:31] sc1
    global_load_dwordx2 v[34:35], v27, s[30:31] sc1
    global_load_dwordx2 v[36:37], v28, s[30:31] sc1
    global_load_dwordx2 v[38:39], v29, s[30:31] sc1
    global_load_dwordx4 v[48:51], v26, s[30:31] offset:0 sc1
    s_waitcnt vmcnt(1)
    v_xor_b32 v16, s33, v33
    v_xor_b32 v17, s33, v37
    v_bitop3_b32 v16, v35, s33, v16 bitop3:0xbe
    v_bitop3_b32 v17, v39, s33, v17 bitop3:0xbe
    v_or_b32 v16, v16, v17
    v_cmp_ne_u32 vcc, 0, v16
    s_cbranch_vccnz L_og_retry
    v_cndmask_b32 v38, 0, v38, s[44:45]
    v_add_f32 v32, v32, v34
    v_add_f32 v36, v36, v38
    v_add_f32 v32, v32, v36
    s_nop 1
    v_add_f32_dpp v32, v32, v32 row_ror:8 row_mask:0xf bank_mask:0xf
    v_mov_b32 v33, v32
    s_nop 1
    v_permlane16_swap_b32 v32, v33
    v_add_f32 v32, v32, v33
    v_cvt_pk_bf16_f32 v32, v32, v32
    v_and_b32 v32, 0xffff0000, v32
    v_mul_f32 v33, 0xbfb8aa3b, v32
    v_exp_f32 v33, v33
    s_nop 0
    v_add_f32 v33, 1.0, v33
    v_rcp_f32 v33, v33
    s_nop 0
    v_mul_f32 v32, v32, v33
    v_cvt_pk_bf16_f32 v32, v32, v32
    v_and_b32 v32, 0xffff0000, v32
    v_lshlrev_b32 v30, 16, v30
    s_branch L_h2_chk
L_h2_retry:
    s_mov_b64 exec, s[72:73]
    global_load_dwordx4 v[48:51], v26, s[30:31] offset:0 sc1
    s_mov_b64 exec, -1
    s_sub_u32 s62, s62, 1
    s_cbranch_scc1 L_fail
L_h2_chk:
    s_waitcnt vmcnt(0)
    v_xor_b32 v16, s33, v49
    v_bitop3_b32 v16, v51, s33, v16 bitop3:0xbe
    v_cmp_ne_u32 s[72:73], 0, v16
    s_nop 0
    s_cmp_lg_u64 s[72:73], 0
    s_cbranch_scc1 L_h2_retry
    v_permlane32_swap_b32 v48, v50
    v_add_f32 v48, v48, v50
    v_mov_b32 v50, v48
    s_nop 1
    v_permlane16_swap_b32 v48, v50
    v_add_f32 v48, v48, v50
    s_nop 1
    v_add_f32_dpp v48, v48, v48 row_ror:8 row_mask:0xf bank_mask:0xf
    v_cvt_pk_bf16_f32 v48, v48, v48
    v_and_b32 v48, 0xffff0000, v48
    v_mul_f32 v48, v48, v32
    v_cvt_pk_bf16_f32 v48, v48, v48
    v_and_b32 v48, 0xffff0000, v48
    v_add_f32 v48, v48, v30
    v_cvt_pk_bf16_f32 v48, v48, v48
    s_mov_b32 exec_lo, 0xff
    s_mov_b32 exec_hi, 0xff
    global_store_short v24, v48, s[26:27]
L_exit:
    s_endpgm
L_Q:
    s_lshl_b32 s50, s6, 10
    s_lshl_b32 s51, s4, 7
    s_add_u32 s50, s50, s51
    s_lshl_b32 s50, s50, 4
    s_add_u32 s50, s50, 4096
    v_add_u32 v25, s50, v9
    v_lshlrev_b32 v26, 3, v0
    v_add_u32 v26, 159488, v26
    v_mov_b32 v43, s33
    s_lshl_b32 s50, s49, 8
    s_add_u32 s50, s50, 4096
    v_lshlrev_b32 v16, 14, v15
    v_lshl_add_u32 v16, v14, 4, v16
    v_add_u32 v30, s50, v16
    s_cmp_eq_u32 s35, 1
    s_cselect_b32 s58, 1, 0
    s_mov_b32 s55, 6
L_spin_17:
    ds_read_b32 v16, v10 offset:32
    s_waitcnt lgkmcnt(0)
    v_cmp_le_u32 vcc, 3, v16
    s_cbranch_vccnz L_spind_18
    s_sleep 1
    s_sub_u32 s62, s62, 1
    s_cbranch_scc0 L_spin_17
    s_branch L_fail
L_spind_18:
    global_load_dwordx4 v[48:51], v25, s[30:31] offset:0 sc1
    global_load_dwordx4 v[52:55], v25, s[30:31] offset:1024 sc1
    s_branch L_q_chk
L_q_retry:
    s_sub_u32 s55, s55, 1
    s_cbranch_scc0 L_q_nohook
    s_cmp_eq_u32 s58, 1
    s_cbranch_scc0 L_nq_skip1
L_nq1:
    global_load_dwordx4 v[56:59], v30, s[30:31] sc1
    s_sub_u32 s62, s62, 1
    s_cbranch_scc1 L_fail
    s_waitcnt vmcnt(0)
    v_xor_b32 v18, s33, v57
    v_xor_b32 v19, s33, v59
    v_or_b32 v18, v18, v19
    v_cmp_ne_u32 vcc, 0, v18
    s_cbranch_vccnz L_nq1
    global_store_dwordx4 v30, v[56:59], s[30:31] sc1
    s_mov_b32 s58, 0
L_nq_skip1:
L_q_nohook:
    s_sleep 4
    s_mov_b64 exec, s[72:73]
    s_cbranch_execz L_q_sk0
    global_load_dwordx4 v[48:51], v25, s[30:31] offset:0 sc1
L_q_sk0:
    s_mov_b64 exec, s[74:75]
    s_cbranch_execz L_q_sk1
    global_load_dwordx4 v[52:55], v25, s[30:31] offset:1024 sc1
L_q_sk1:
    s_mov_b64 exec, -1
    s_sub_u32 s62, s62, 1
    s_cbranch_scc1 L_fail
L_q_chk:
    s_waitcnt vmcnt(0)
    v_xor_b32 v16, s33, v49
    v_xor_b32 v17, s33, v53
    v_bitop3_b32 v16, v51, s33, v16 bitop3:0xbe
    v_bitop3_b32 v17, v55, s33, v17 bitop3:0xbe
    v_cmp_ne_u32 s[72:73], 0, v16
    v_cmp_ne_u32 s[74:75], 0, v17
    s_nop 0
    s_or_b64 vcc, s[72:73], s[74:75]
    s_cbranch_scc1 L_q_retry
    ds_write2_b32 v26, v48, v50 offset0:0 offset1:1
    ds_write2_b32 v26, v52, v54 offset0:128 offset1:129
    v_mov_b32 v16, 1
    ds_write_b32 v10, v16 offset:64
    v_and_b32 v17, 1, v0
    v_lshlrev_b32 v16, 4, v17
    v_add_u32 v18, s6, v15
    v_and_b32 v18, 3, v18
    v_lshlrev_b32 v18, 13, v18
    v_lshrrev_b32 v19, 1, v14
    v_lshl_add_u32 v18, v19, 7, v18
    v_add_u32 v18, v18, v16
    s_lshl_b32 s50, s4, 10
    s_add_u32 s50, s50, 524288
    v_add_u32 v25, s50, v18
    s_lshl_b32 s51, s6, 13
    s_add_u32 s50, s50, s51
    s_lshl_b32 s51, s7, 7
    s_add_u32 s50, s50, s51
    v_add_u32 v24, s50, v16
    v_add_u32 v27, v16, v10
    v_lshl_add_u32 v28, v17, 2, v10
    s_getreg_b32 s52, hwreg(HW_REG_XCC_ID, 0, 4)
    s_xor_b32 s53, s52, s33
    v_mov_b32 v41, s53
L_spin4_19:
    ds_read_b128 v[44:47], v10 offset:96
    s_waitcnt lgkmcnt(0)
    v_min_u32 v44, v44, v45
    v_min3_u32 v44, v44, v46, v47
    v_cmp_ne_u32 vcc, 0, v44
    s_cbranch_vccnz L_spin4d_20
    s_sleep 4
    s_sub_u32 s62, s62, 1
    s_cbranch_scc0 L_spin4_19
    s_branch L_fail
L_spin4d_20:
    ds_read_b128 v[44:47], v27 offset:128
    ds_read_b128 v[48:51], v27 offset:160
    s_waitcnt lgkmcnt(0)
    v_max_f32 v40, v44, v45
    v_max3_f32 v40, v40, v46, v47
    v_add_f32 v48, v48, v49
    v_add_f32 v50, v50, v51
    v_add_f32 v42, v48, v50
    s_mov_b64 exec, 3
    global_store_dwordx4 v24, v[40:43], s[30:31]
    s_mov_b64 exec, -1
    s_mov_b32 s55, 10
    s_branch L_ml_first
L_ml_retry:
    s_sub_u32 s62, s62, 1
    s_cbranch_scc1 L_fail
    s_cmp_eq_u32 s55, 1000
    s_cbranch_scc1 L_ml_again
    s_and_b32 s59, s56, 0xffff
    s_cbranch_scc1 L_ml_pub
    s_sub_u32 s55, s55, 1
    s_cbranch_scc0 L_ml_again
L_ml_pub:
    s_mov_b64 exec, 3
    global_store_dwordx4 v24, v[40:43], s[30:31] sc1
    s_mov_b64 exec, -1
    s_cmp_eq_u32 s58, 1
    s_cbranch_scc0 L_nq_skip2
L_nq2:
    global_load_dwordx4 v[56:59], v30, s[30:31] sc1
    s_sub_u32 s62, s62, 1
    s_cbranch_scc1 L_fail
    s_waitcnt vmcnt(0)
    v_xor_b32 v18, s33, v57
    v_xor_b32 v19, s33, v59
    v_or_b32 v18, v18, v19
    v_cmp_ne_u32 vcc, 0, v18
    s_cbranch_vccnz L_nq2
    global_store_dwordx4 v30, v[56:59], s[30:31] sc1
    s_mov_b32 s58, 0
L_nq_skip2:
    s_movk_i32 s55, 1000
L_ml_again:
    s_sleep 2
L_ml_first:
    global_load_dwordx4 v[48:51], v25, s[30:31] sc1
    s_waitcnt vmcnt(0)
    v_xor_b32 v16, s33, v49
    v_lshrrev_b32 v17, 4, v16
    v_bitop3_b32 v17, v51, s33, v17 bitop3:0xbe
    v_cmp_ne_u32 s[56:57], s52, v16
    v_cmp_ne_u32 s[60:61], 0, v17
    s_nop 0
    s_andn2_b64 s[56:57], s[56:57], s[60:61]
    s_and_b32 s59, s60, 0xffff
    s_cbranch_scc1 L_ml_retry
    s_and_b32 s59, s56, 0xffff
    s_cselect_b32 s54, 0, 1
    s_cbranch_scc0 L_ml_ok
    s_mov_b64 exec, 3
    global_store_dwordx4 v24, v[40:43], s[30:31] sc1
    s_mov_b64 exec, -1
L_ml_ok:
    s_mov_b32 s50, 0x3db8aa3b
    v_mov_b32 v44, v48
    s_nop 1
    v_max_f32_dpp v44, v44, v44 quad_perm:[2,3,0,1] row_mask:0xf bank_mask:0xf
    s_nop 1
    v_max_f32_dpp v44, v44, v44 row_ror:4 row_mask:0xf bank_mask:0xf
    s_nop 1
    v_max_f32_dpp v44, v44, v44 row_ror:8 row_mask:0xf bank_mask:0xf
    v_sub_f32 v45, v48, v44
    v_sub_f32 v46, v40, v44
    v_mul_f32 v45, s50, v45
    v_mul_f32 v46, s50, v46
    v_exp_f32 v45, v45
    v_exp_f32 v46, v46
    v_mul_f32 v45, v45, v50
    s_nop 1
    v_add_f32_dpp v45, v45, v45 quad_perm:[2,3,0,1] row_mask:0xf bank_mask:0xf
    s_nop 1
    v_add_f32_dpp v45, v45, v45 row_ror:4 row_mask:0xf bank_mask:0xf
    s_nop 1
    v_add_f32_dpp v45, v45, v45 row_ror:8 row_mask:0xf bank_mask:0xf
    v_rcp_f32 v45, v45
    v_mov_b32 v17, s54
    v_mul_f32 v46, v46, v45
    v_mov_b32 v20, 1
    s_mov_b64 exec, 3
    ds_write_b32 v28, v46 offset:192
    ds_write_b32 v10, v17 offset:200
    ds_write_b32 v10, v20 offset:112
    s_mov_b64 exec, -1
    s_cmp_eq_u32 s35, 4
    s_cselect_b32 s59, 1, s58
    s_cmp_eq_u32 s59, 0
    s_cbranch_scc1 L_q_exit
    s_mov_b32 s55, 4
L_spin_21:
    ds_read_b32 v16, v10 offset:32
    s_waitcnt lgkmcnt(0)
    v_cmp_le_u32 vcc, 24, v16
    s_cbranch_vccnz L_spind_22
    s_sleep 8
    s_sub_u32 s62, s62, 1
    s_cbranch_scc0 L_spin_21
    s_branch L_fail
L_spind_22:
L_all:
    s_cmp_lg_u64 s[56:57], 0
    s_cbranch_scc1 L_all_no
    s_cmp_eq_u64 s[60:61], 0
    s_cbranch_scc1 L_all_yes
    s_sub_u32 s55, s55, 1
    s_cbranch_scc1 L_all_no
    s_sleep 8
    global_load_dwordx4 v[48:51], v25, s[30:31] sc1
    s_waitcnt vmcnt(0)
    v_xor_b32 v16, s33, v49
    v_lshrrev_b32 v17, 4, v16
    v_bitop3_b32 v17, v51, s33, v17 bitop3:0xbe
    v_cmp_ne_u32 s[56:57], s52, v16
    v_cmp_ne_u32 s[60:61], 0, v17
    s_nop 0
    s_andn2_b64 s[56:57], s[56:57], s[60:61]
    s_branch L_all
L_all_no:
    s_cmp_eq_u32 s58, 1
    s_cbranch_scc0 L_nq_skip3
L_nq3:
    global_load_dwordx4 v[56:59], v30, s[30:31] sc1
    s_sub_u32 s62, s62, 1
    s_cbranch_scc1 L_fail
    s_waitcnt vmcnt(0)
    v_xor_b32 v18, s33, v57
    v_xor_b32 v19, s33, v59
    v_or_b32 v18, v18, v19
    v_cmp_ne_u32 vcc, 0, v18
    s_cbranch_vccnz L_nq3
    global_store_dwordx4 v30, v[56:59], s[30:31] sc1
    s_mov_b32 s58, 0
L_nq_skip3:
    v_mov_b32 v20, 2
L_all_yes:
    ds_write_b32 v10, v20 offset:204
L_q_exit:
    s_endpgm
L_F:
    s_cmp_eq_u32 s2, 255
    s_cbranch_scc1 L_E
    s_cmp_eq_u32 s35, 4
    s_cbranch_scc0 L_end
    v_lshrrev_b32 v16, 2, v14
    v_lshl_add_u32 v16, v15, 3, v16
    v_lshlrev_b32 v16, 7, v16
    v_and_b32 v17, 1, v14
    v_lshl_add_u32 v16, v17, 3, v16
    v_and_b32 v17, 1, v15
    v_lshrrev_b32 v18, 3, v14
    v_lshl_add_u32 v17, v17, 1, v18
    v_lshlrev_b32 v17, 1, v17
    v_bfe_u32 v18, v14, 1, 1
    v_xor_b32 v17, v17, v18
    v_lshl_add_u32 v20, v17, 4, v16
    v_add_u32 v20, 131072, v20
    v_xor_b32 v21, 32, v20
    v_xor_b32 v22, 64, v20
    v_xor_b32 v23, 96, v20
    s_lshl_b32 s52, s5, 12
    s_add_u32 s52, s52, 131072
    v_add_u32 v25, s52, v9
    s_mul_i32 s52, s5, 28
    s_add_u32 s52, s52, s4
    s_lshl_b32 s52, s52, 9
    s_add_u32 s52, s52, 262144
    v_and_b32 v17, 3, v14
    v_lshrrev_b32 v18, 2, v14
    v_lshlrev_b32 v18, 6, v18
    v_lshl_add_u32 v18, v15, 4, v18
    s_movk_i32 s51, 3584
    v_mad_u32_u24 v16, v17, s51, v18
    v_add_u32 v24, s52, v16
    v_bfe_u32 v16, v0, 2, 2
    v_lshlrev_b32 v16, 8, v16
    v_lshl_add_u32 v16, v15, 5, v16
    v_lshl_add_u32 v26, v17, 3, v16
    v_add_u32 v26, 162560, v26
    v_lshlrev_b32 v16, 8, v17
    v_lshl_add_u32 v27, v15, 4, v16
    v_add_u32 v27, 162560, v27
    s_mov_b32 s44, 0xf0f0f0f0
    s_mov_b32 s45, 0xf0f0f0f0
    s_mov_b32 s46, 0xff00ff00
    s_mov_b32 s47, 0xff00ff00
L_spin_23:
    ds_read_b32 v16, v10 offset:32
    s_waitcnt lgkmcnt(0)
    v_cmp_le_u32 vcc, 1, v16
    s_cbranch_vccnz L_spind_24
    s_sleep 2
    s_sub_u32 s62, s62, 1
    s_cbranch_scc0 L_spin_23
    s_branch L_fail
L_spind_24:
    ds_read_b64_tr_b16 v[128:129], v20 offset:0
    ds_read_b64_tr_b16 v[130:131], v20 offset:512
    ds_read_b64_tr_b16 v[132:133], v21 offset:0
    ds_read_b64_tr_b16 v[134:135], v21 offset:512
    ds_read_b64_tr_b16 v[136:137], v22 offset:0
    ds_read_b64_tr_b16 v[138:139], v22 offset:512
    ds_read_b64_tr_b16 v[140:141], v23 offset:0
    ds_read_b64_tr_b16 v[142:143], v23 offset:512
    ds_read_b64_tr_b16 v[144:145], v20 offset:4096
    ds_read_b64_tr_b16 v[146:147], v20 offset:4608
    ds_read_b64_tr_b16 v[148:149], v21 offset:4096
    ds_read_b64_tr_b16 v[150:151], v21 offset:4608
    ds_read_b64_tr_b16 v[152:153], v22 offset:4096
    ds_read_b64_tr_b16 v[154:155], v22 offset:4608
    ds_read_b64_tr_b16 v[156:157], v23 offset:4096
    ds_read_b64_tr_b16 v[158:159], v23 offset:4608
    ds_read_b64_tr_b16 v[160:161], v20 offset:8192
    ds_read_b64_tr_b16 v[162:163], v20 offset:8704
    ds_read_b64_tr_b16 v[164:165], v21 offset:8192
    ds_read_b64_tr_b16 v[166:167], v21 offset:8704
    ds_read_b64_tr_b16 v[168:169], v22 offset:8192
    ds_read_b64_tr_b16 v[170:171], v22 offset:8704
    ds_read_b64_tr_b16 v[172:173], v23 offset:8192
    ds_read_b64_tr_b16 v[174:175], v23 offset:8704
    ds_read_b64_tr_b16 v[176:177], v20 offset:12288
    ds_read_b64_tr_b16 v[178:179], v20 offset:12800
    ds_read_b64_tr_b16 v[180:181], v21 offset:12288
    ds_read_b64_tr_b16 v[182:183], v21 offset:12800
    ds_read_b64_tr_b16 v[184:185], v22 offset:12288
    ds_read_b64_tr_b16 v[186:187], v22 offset:12800
    ds_read_b64_tr_b16 v[188:189], v23 offset:12288
    ds_read_b64_tr_b16 v[190:191], v23 offset:12800
    v_mov_b32 v16, 1000
    s_waitcnt lgkmcnt(0)
    ds_write_b32 v10, v16 offset:16
L_spin_25:
    ds_read_b32 v16, v10 offset:32
    s_waitcnt lgkmcnt(0)
    v_cmp_le_u32 vcc, 28, v16
    s_cbranch_vccnz L_spind_26
    s_sleep 8
    s_sub_u32 s62, s62, 1
    s_cbranch_scc0 L_spin_25
    s_branch L_fail
L_spind_26:
L_h_retry:
    global_load_dwordx4 v[64:67], v25, s[30:31] offset:0 sc1
    global_load_dwordx4 v[68:71], v25, s[30:31] offset:1024 sc1
    global_load_dwordx4 v[72:75], v25, s[30:31] offset:2048 sc1
    global_load_dwordx4 v[76:79], v25, s[30:31] offset:3072 sc1
    s_sub_u32 s62, s62, 1
    s_cbranch_scc1 L_fail
    s_waitcnt vmcnt(0)
    v_xor_b32 v16, s33, v65
    v_xor_b32 v17, s33, v73
    v_bitop3_b32 v16, v67, s33, v16 bitop3:0xbe
    v_bitop3_b32 v17, v75, s33, v17 bitop3:0xbe
    v_bitop3_b32 v16, v69, s33, v16 bitop3:0xbe
    v_bitop3_b32 v17, v77, s33, v17 bitop3:0xbe
    v_bitop3_b32 v16, v71, s33, v16 bitop3:0xbe
    v_bitop3_b32 v17, v79, s33, v17 bitop3:0xbe
    v_or_b32 v16, v16, v17
    v_cmp_ne_u32 vcc, 0, v16
    s_cbranch_vccnz L_h_retry
    v_lshlrev_b32 v84, 16, v64
    v_and_b32 v85, 0xffff0000, v64
    v_lshlrev_b32 v92, 16, v72
    v_and_b32 v93, 0xffff0000, v72
    v_lshlrev_b32 v86, 16, v66
    v_and_b32 v87, 0xffff0000, v66
    v_lshlrev_b32 v94, 16, v74
    v_and_b32 v95, 0xffff0000, v74
    v_lshlrev_b32 v88, 16, v68
    v_and_b32 v89, 0xffff0000, v68
    v_lshlrev_b32 v96, 16, v76
    v_and_b32 v97, 0xffff0000, v76
    v_lshlrev_b32 v90, 16, v70
    v_and_b32 v91, 0xffff0000, v70
    v_lshlrev_b32 v98, 16, v78
    v_and_b32 v99, 0xffff0000, v78
    s_mov_b32 s50, 0xbfb8aa3b
    v_mul_f32 v100, s50, v84
    v_mul_f32 v101, s50, v85
    v_mul_f32 v102, s50, v86
    v_mul_f32 v103, s50, v87
    v_mul_f32 v104, s50, v88
    v_mul_f32 v105, s50, v89
    v_mul_f32 v106, s50, v90
    v_mul_f32 v107, s50, v91
    v_exp_f32 v100, v100
    v_exp_f32 v101, v101
    v_exp_f32 v102, v102
    v_exp_f32 v103, v103
    v_exp_f32 v104, v104
    v_exp_f32 v105, v105
    v_exp_f32 v106, v106
    v_exp_f32 v107, v107
    v_add_f32 v100, 1.0, v100
    v_add_f32 v101, 1.0, v101
    v_add_f32 v102, 1.0, v102
    v_add_f32 v103, 1.0, v103
    v_add_f32 v104, 1.0, v104
    v_add_f32 v105, 1.0, v105
    v_add_f32 v106, 1.0, v106
    v_add_f32 v107, 1.0, v107
    v_rcp_f32 v100, v100
    v_rcp_f32 v101, v101
    v_rcp_f32 v102, v102
    v_rcp_f32 v103, v103
    v_rcp_f32 v104, v104
    v_rcp_f32 v105, v105
    v_rcp_f32 v106, v106
    v_rcp_f32 v107, v107
    v_mul_f32 v100, v100, v84
    v_mul_f32 v101, v101, v85
    v_mul_f32 v102, v102, v86
    v_mul_f32 v103, v103, v87
    v_mul_f32 v104, v104, v88
    v_mul_f32 v105, v105, v89
    v_mul_f32 v106, v106, v90
    v_mul_f32 v107, v107, v91
    v_cvt_pk_bf16_f32 v100, v100, v100
    v_and_b32 v100, 0xffff0000, v100
    v_cvt_pk_bf16_f32 v101, v101, v101
    v_and_b32 v101, 0xffff0000, v101
    v_cvt_pk_bf16_f32 v102, v102, v102
    v_and_b32 v102, 0xffff0000, v102
    v_cvt_pk_bf16_f32 v103, v103, v103
    v_and_b32 v103, 0xffff0000, v103
    v_cvt_pk_bf16_f32 v104, v104, v104
    v_and_b32 v104, 0xffff0000, v104
    v_cvt_pk_bf16_f32 v105, v105, v105
    v_and_b32 v105, 0xffff0000, v105
    v_cvt_pk_bf16_f32 v106, v106, v106
    v_and_b32 v106, 0xffff0000, v106
    v_cvt_pk_bf16_f32 v107, v107, v107
    v_and_b32 v107, 0xffff0000, v107
    v_mul_f32 v100, v100, v92
    v_mul_f32 v101, v101, v93
    v_mul_f32 v102, v102, v94
    v_mul_f32 v103, v103, v95
    v_mul_f32 v104, v104, v96
    v_mul_f32 v105, v105, v97
    v_mul_f32 v106, v106, v98
    v_mul_f32 v107, v107, v99
    v_cvt_pk_bf16_f32 v108, v100, v101
    v_cvt_pk_bf16_f32 v109, v102, v103
    v_cvt_pk_bf16_f32 v110, v104, v105
    v_cvt_pk_bf16_f32 v111, v106, v107
    ds_write_b64 v26, v[108:109]
    ds_write_b64 v26, v[110:111] offset:128
    ds_read_b128 v[64:67], v27 offset:0
    ds_read_b128 v[68:71], v27 offset:64
    ds_read_b128 v[72:75], v27 offset:128
    ds_read_b128 v[76:79], v27 offset:192
    s_waitcnt lgkmcnt(0)
    v_mfma_f32_16x16x32_bf16 v[84:87], v[128:131], v[64:67], 0
    v_mfma_f32_16x16x32_bf16 v[88:91], v[132:135], v[64:67], 0
    v_mfma_f32_16x16x32_bf16 v[92:95], v[136:139], v[64:67], 0
    v_mfma_f32_16x16x32_bf16 v[96:99], v[140:143], v[64:67], 0
    v_mfma_f32_16x16x32_bf16 v[84:87], v[144:147], v[68:71], v[84:87]
    v_mfma_f32_16x16x32_bf16 v[88:91], v[148:151], v[68:71], v[88:91]
    v_mfma_f32_16x16x32_bf16 v[92:95], v[152:155], v[68:71], v[92:95]
    v_mfma_f32_16x16x32_bf16 v[96:99], v[156:159], v[68:71], v[96:99]
    v_mfma_f32_16x16x32_bf16 v[84:87], v[160:163], v[72:75], v[84:87]
    v_mfma_f32_16x16x32_bf16 v[88:91], v[164:167], v[72:75], v[88:91]
    v_mfma_f32_16x16x32_bf16 v[92:95], v[168:171], v[72:75], v[92:95]
    v_mfma_f32_16x16x32_bf16 v[96:99], v[172:175], v[72:75], v[96:99]
    v_mfma_f32_16x16x32_bf16 v[84:87], v[176:179], v[76:79], v[84:87]
    v_mfma_f32_16x16x32_bf16 v[88:91], v[180:183], v[76:79], v[88:91]
    v_mfma_f32_16x16x32_bf16 v[92:95], v[184:187], v[76:79], v[92:95]
    v_mfma_f32_16x16x32_bf16 v[96:99], v[188:191], v[76:79], v[96:99]
    v_mov_b32 v41, s33
    v_mov_b32 v43, s33
    v_mov_b32 v45, s33
    v_mov_b32 v47, s33
    s_nop 1
    v_cndmask_b32 v16, v84, v88, s[44:45]
    s_nop 0
    v_cndmask_b32 v17, v92, v96, s[44:45]
    v_cndmask_b32 v40, v16, v17, s[46:47]
    v_cndmask_b32 v16, v85, v89, s[44:45]
    v_cndmask_b32 v17, v93, v97, s[44:45]
    v_cndmask_b32 v42, v16, v17, s[46:47]
    v_cndmask_b32 v16, v86, v90, s[44:45]
    v_cndmask_b32 v17, v94, v98, s[44:45]
    v_cndmask_b32 v44, v16, v17, s[46:47]
    v_cndmask_b32 v16, v87, v91, s[44:45]
    v_cndmask_b32 v17, v95, v99, s[44:45]
    v_cndmask_b32 v46, v16, v17, s[46:47]
L_spin_27:
    ds_read_b32 v16, v10 offset:204
    s_waitcnt lgkmcnt(0)
    v_cmp_le_u32 vcc, 1, v16
    s_cbranch_vccnz L_spind_28
    s_sleep 2
    s_sub_u32 s62, s62, 1
    s_cbranch_scc0 L_spin_27
    s_branch L_fail
L_spind_28:
    v_cmp_eq_u32 vcc, 1, v16
    s_cbranch_vccz L_og_far
    global_store_dwordx4 v24, v[40:43], s[30:31]
    global_store_dwordx4 v24, v[44:47], s[30:31] offset:256
    s_branch L_exit
L_og_far:
    global_store_dwordx4 v24, v[40:43], s[30:31] sc1
    global_store_dwordx4 v24, v[44:47], s[30:31] offset:256 sc1
    s_branch L_exit
L_E:
    v_add_u32 v28, 2097152, v9
    v_add_u32 v29, 2125824, v9
    v_add_u32 v30, 2154496, v9
    v_add_u32 v31, 2183168, v9
L_spin_29:
    ds_read_b32 v16, v10 offset:32
    s_waitcnt lgkmcnt(0)
    v_cmp_le_u32 vcc, 33, v16
    s_cbranch_vccnz L_spind_30
    s_sleep 16
    s_sub_u32 s62, s62, 1
    s_cbranch_scc0 L_spin_29
    s_branch L_fail
L_spind_30:
    global_load_dwordx4 v[48:51], v28, s[30:31] offset:0 sc1
    global_load_dwordx4 v[52:55], v29, s[30:31] offset:0 sc1
    global_load_dwordx4 v[56:59], v30, s[30:31] offset:0 sc1
    global_load_dwordx4 v[60:63], v31, s[30:31] offset:0 sc1
    s_branch L_ew_chk
L_ew_retry:
    s_mov_b64 exec, s[72:73]
    s_cbranch_execz L_ew_sk0
    global_load_dwordx4 v[48:51], v28, s[30:31] offset:0 sc1
L_ew_sk0:
    s_mov_b64 exec, s[74:75]
    s_cbranch_execz L_ew_sk1
    global_load_dwordx4 v[52:55], v29, s[30:31] offset:0 sc1
L_ew_sk1:
    s_mov_b64 exec, s[76:77]
    s_cbranch_execz L_ew_sk2
    global_load_dwordx4 v[56:59], v30, s[30:31] offset:0 sc1
L_ew_sk2:
    s_mov_b64 exec, s[78:79]
    s_cbranch_execz L_ew_sk3
    global_load_dwordx4 v[60:63], v31, s[30:31] offset:0 sc1
L_ew_sk3:
    s_mov_b64 exec, -1
    s_sub_u32 s62, s62, 1
    s_cbranch_scc1 L_fail
L_ew_chk:
    s_waitcnt vmcnt(0)
    v_xor_b32 v16, s33, v49
    v_xor_b32 v17, s33, v53
    v_xor_b32 v18, s33, v57
    v_xor_b32 v19, s33, v61
    v_bitop3_b32 v16, v51, s33, v16 bitop3:0xbe
    v_bitop3_b32 v17, v55, s33, v17 bitop3:0xbe
    v_bitop3_b32 v18, v59, s33, v18 bitop3:0xbe
    v_bitop3_b32 v19, v63, s33, v19 bitop3:0xbe
    v_cmp_ne_u32 s[72:73], 0, v16
    v_cmp_ne_u32 s[74:75], 0, v17
    v_cmp_ne_u32 s[76:77], 0, v18
    v_cmp_ne_u32 s[78:79], 0, v19
    s_or_b64 vcc, s[72:73], s[74:75]
    s_or_b64 vcc, vcc, s[76:77]
    s_or_b64 vcc, vcc, s[78:79]
    s_cbranch_scc1 L_ew_retry
    s_mov_b64 exec, 1
    v_mov_b32 v16, 0
    v_mov_b32 v17, s33
    global_store_dword v16, v17, s[30:31] sc1
    s_branch L_exit
L_end:
    s_endpgm
L_fail:
    s_mov_b64 exec, 1
    s_lshl_b32 s60, s3, 2
    s_or_b32 s61, s2, 0xbad00000
    v_mov_b32 v16, s60
    v_mov_b32 v17, s61
    global_store_dword v16, v17, s[28:29]
    s_endpgm
.section .rodata,"a"
.p2align 6
.amdhsa_kernel recurrent_scan__gqa_block_cached__glu_gated_swiglu__decode_kernel
  .amdhsa_next_free_vgpr 256
  .amdhsa_next_free_sgpr 96
  .amdhsa_accum_offset 256
  .amdhsa_group_segment_fixed_size 0
  .amdhsa_kernarg_size 96
  .amdhsa_user_sgpr_count 2
  .amdhsa_user_sgpr_kernarg_segment_ptr 1
  .amdhsa_system_sgpr_workgroup_id_x 1
.end_amdhsa_kernel
```
